```python
import torch

def _softmax(x, axis=-1):
    return torch.softmax(x, dim=axis)
def _gelu(x):
    return torch.nn.functional.gelu(x, approximate="tanh")
def _silu(x):
    return torch.nn.functional.silu(x)
def _sigmoid(x):
    return torch.sigmoid(x)
def _layernorm(x, axis=-1, eps=1e-5):
    m = x.mean(dim=axis, keepdim=True)
    v = x.var(dim=axis, keepdim=True, unbiased=False)
    return (x - m) / torch.sqrt(v + eps)
def _scatter_add(tgt, idx, src, axis=0):
    return tgt.clone().index_add_(axis, idx, src)
def _segment_sum(src, seg, n):
    out = torch.zeros((n,) + src.shape[1:], dtype=src.dtype)
    return out.index_add_(0, seg, src)
def _pad(x, pw):
    flat = tuple(v for pair in reversed(pw) for v in pair)
    return torch.nn.functional.pad(x, flat)

kernel_name = 'parallel_sum__sliding_block_cached__mixer_channel_mlp__decode'

def setup_inputs():

    _w = (lambda a: (lambda t: t.to(torch.bfloat16) if t.is_floating_point() else t)(torch.as_tensor(a)))
    def _A_setup():
        B, Sq, D = 1, 1, 448
        Hq, Hkv, Sk, Dh = 16, 8, 8192, 256
        assert Hq % Hkv == 0, (Hq, Hkv)
        return {
            "x": _w((lambda *s: torch.randn(*s, dtype=torch.bfloat16) * 0.05)(B, Sq, D)),
            "k_cache": _w((lambda *s: torch.randn(*s, dtype=torch.bfloat16) * 3.2)(B, Hkv, Sk, Dh)),
            "v_cache": _w((lambda *s: torch.randn(*s, dtype=torch.bfloat16) * 0.4)(B, Hkv, Sk, Dh)),
            "wq": _w((lambda *s: torch.randn(*s, dtype=torch.bfloat16) * 3.2)(D, Hq * Dh) * (D ** -0.5)),
            "wo": _w((lambda *s: torch.randn(*s, dtype=torch.bfloat16) * 0.4)(Hq * Dh, D) * ((Hq * Dh) ** -0.5)),
        }
    _A_in = _A_setup()

    def _B_setup():
        B, S, D, F = 1, 1, 448, 1792
        return {
            "x": _w((lambda *s: torch.randn(*s, dtype=torch.bfloat16) * 0.05)(B, S, D)),
            "w1": _w((lambda *s: torch.randn(*s, dtype=torch.bfloat16) * 3.2)(D, F) * (D ** -0.5)),
            "b1": _w((lambda *s: torch.randn(*s, dtype=torch.bfloat16) * 1.6)(F)),
            "w2": _w((lambda *s: torch.randn(*s, dtype=torch.bfloat16) * 0.05)(F, D) * (F ** -0.5)),
            "b2": _w((lambda *s: torch.randn(*s, dtype=torch.bfloat16) * 0.05)(D)),
        }
    _B_in = _B_setup()

    return {
        "A_x": _A_in["x"],
        "A_k_cache": _A_in["k_cache"],
        "A_v_cache": _A_in["v_cache"],
        "A_wq": _A_in["wq"],
        "A_wo": _A_in["wo"],
        "B_x": _B_in["x"],
        "B_w1": _B_in["w1"],
        "B_b1": _B_in["b1"],
        "B_w2": _B_in["w2"],
        "B_b2": _B_in["b2"],
    }

def reference(A_x, A_k_cache, A_v_cache, A_wq, A_wo, B_x, B_w1, B_b1, B_w2, B_b2):
    def _A_ref(x, k_cache, v_cache, wq, wo):
        B, Sq, D = x.shape
        Hq, Dh = 16, 256
        Hkv, Sk = k_cache.shape[1], k_cache.shape[2]
        W = min(4096, max(256, Sk // 4))
        rep = Hq // Hkv
        q = (lambda x, *d: x.permute(*d))((x @ wq).reshape(B, Sq, Hq, Dh), 0, 2, 1, 3)
        k = (lambda x, n, axis: torch.repeat_interleave(x, n, dim=axis))(k_cache[:, :, Sk - W:, :], rep, axis=1)
        v = (lambda x, n, axis: torch.repeat_interleave(x, n, dim=axis))(v_cache[:, :, Sk - W:, :], rep, axis=1)
        scores = torch.einsum("bhqd,bhkd->bhqk", q, k) * (Dh ** -0.5)
        p = _softmax(scores, axis=-1)
        o = torch.einsum("bhqk,bhkd->bhqd", p, v)
        return (lambda x, *d: x.permute(*d))(o, 0, 2, 1, 3).reshape(B, Sq, Hq * Dh) @ wo

    def _B_ref(x, w1, b1, w2, b2):
        y = _layernorm(x, axis=-1)
        h = _gelu(torch.einsum("bsd,df->bsf", y, w1) + b1)
        return torch.einsum("bsf,fd->bsd", h, w2) + b2

    x = A_x
    xn = _layernorm(x, axis=-1)
    return x + _A_ref(xn, A_k_cache, A_v_cache, A_wq, A_wo) + _B_ref(xn, B_w1, B_b1, B_w2, B_b2)
```

```asm
; @launch grid=(256,1,1) block=(512,1,1) lds=22528
.amdgcn_target "amdgcn-amd-amdhsa--gfx950"
.text
.globl parallel_sum__sliding_block_cached__mixer_channel_mlp__decode_kernel
.p2align 8
.type parallel_sum__sliding_block_cached__mixer_channel_mlp__decode_kernel,@function
parallel_sum__sliding_block_cached__mixer_channel_mlp__decode_kernel:
    s_cmp_ge_u32 s2, 256
    s_cbranch_scc1 L_end
    s_load_dwordx16 s[4:19], s[0:1], 0
    s_load_dwordx8 s[20:27], s[0:1], 64
    s_load_dwordx2 s[28:29], s[0:1], 96
    v_lshrrev_b32 v1, 6, v0
    v_and_b32 v0, 63, v0
    v_readfirstlane_b32 s3, v1
    s_and_b32 s30, s2, 7
    s_lshr_b32 s31, s2, 3
    s_add_u32 s3, s3, 7
    s_and_b32 s3, s3, 7
    s_mov_b32 s32, 0x05040100
    s_mov_b32 s33, 0x07060302
    s_mov_b32 s44, 0
    s_cmp_eq_u32 s3, 7
    s_cbranch_scc1 L_service
    s_cmp_lt_u32 s31, 16
    s_cbranch_scc1 L_X
    s_cmp_lt_u32 s31, 24
    s_cbranch_scc1 L_Yq
    s_cmp_lt_u32 s31, 31
    s_cbranch_scc1 L_Ym
    s_branch L_Ys
L_X:
    s_mul_i32 s35, s31, 7
    s_add_u32 s35, s35, s3
    s_lshl_b32 s35, s35, 13
    s_lshl_b32 s45, s30, 22
    s_add_u32 s35, s35, s45
    s_add_u32 s35, s35, 0x300000
    v_and_b32 v2, 7, v0
    v_lshlrev_b32 v2, 9, v2
    v_lshrrev_b32 v3, 3, v0
    v_lshl_add_u32 v2, v3, 4, v2
    v_lshlrev_b32 v3, 4, v0
    s_waitcnt lgkmcnt(0)
    s_add_u32 s36, s6, s35
    s_addc_u32 s37, s7, 0
    s_add_u32 s38, s36, 4096
    s_addc_u32 s39, s37, 0
    s_add_u32 s40, s8, s35
    s_addc_u32 s41, s9, 0
    s_add_u32 s42, s40, 4096
    s_addc_u32 s43, s41, 0
    global_load_dwordx4 v[32:35], v2, s[36:37] offset:0 nt
    global_load_dwordx4 v[36:39], v2, s[36:37] offset:128 nt
    global_load_dwordx4 v[40:43], v2, s[36:37] offset:256 nt
    global_load_dwordx4 v[44:47], v2, s[36:37] offset:384 nt
    global_load_dwordx4 v[48:51], v2, s[38:39] offset:0 nt
    global_load_dwordx4 v[52:55], v2, s[38:39] offset:128 nt
    global_load_dwordx4 v[56:59], v2, s[38:39] offset:256 nt
    global_load_dwordx4 v[60:63], v2, s[38:39] offset:384 nt
    s_load_dword s34, s[28:29], 0
    v_and_b32 v6, 1, v0
    v_mul_u32_u24 v6, 640, v6
    v_lshrrev_b32 v7, 4, v0
    v_lshlrev_b32 v7, 5, v7
    v_bfe_u32 v8, v0, 1, 1
    v_lshl_add_u32 v7, v8, 4, v7
    v_add_u32 v6, v6, v7
    v_add_u32 v7, 1280, v7
    v_bfe_u32 v8, v0, 2, 2
    v_cmp_eq_u32 vcc, 0, v8
    s_nop 1
    v_cndmask_b32 v4, v7, v6, vcc
    v_cmp_eq_u32 vcc, 1, v8
    s_nop 1
    v_cndmask_b32 v5, v7, v6, vcc
    v_mov_b32 v15, 0xff800000
    s_mov_b32 s46, 0x00ff00ff
    s_mov_b32 s47, 0x00ff00ff
    v_lshrrev_b32 v31, 5, v0
    v_lshlrev_b32 v29, 5, v31
    s_lshl_b32 s35, s3, 2
    v_add_u32 v28, s35, v29
    v_lshlrev_b32 v31, 2, v31
    s_lshl_b32 s35, s3, 11
    v_lshl_add_u32 v30, v0, 5, s35
    s_lshl_b32 s35, s30, 5
    s_add_u32 s35, s35, s31
    s_mul_i32 s35, s35, 2176
    s_add_u32 s45, s35, 524288
    s_add_u32 s56, s28, s45
    s_addc_u32 s57, s29, 0
    s_add_u32 s35, s35, 1540096
    s_mul_i32 s45, s3, 192
    s_add_u32 s35, s35, s45
    s_add_u32 s58, s28, s35
    s_addc_u32 s59, s29, 0
    s_lshr_b32 s35, s3, 2
    s_mul_i32 s35, s35, 640
    s_and_b32 s45, s3, 3
    s_lshl_b32 s45, s45, 7
    s_add_u32 s35, s35, s45
    v_lshl_add_u32 v19, v0, 2, s35
    s_lshl_b32 s35, s3, 8
    v_lshl_add_u32 v17, v0, 2, s35
    s_min_u32 s35, s31, 1
    s_lshl_b32 s45, s30, 1
    s_add_u32 s45, s45, s35
    s_min_u32 s45, s45, 13
    v_and_b32 v20, 31, v0
    s_lshl_b32 s35, s45, 5
    v_add_u32 v20, s35, v20
    v_lshlrev_b32 v20, 1, v20
    s_lshl_b32 s35, s45, 14
    s_lshl_b32 s45, s3, 11
    s_add_u32 s35, s35, s45
    s_add_u32 s35, s35, 1310720
    s_add_u32 s52, s28, s35
    s_addc_u32 s53, s29, 0
    s_lshl_b32 s35, s3, 6
    s_add_u32 s35, s35, 4096
    s_add_u32 s48, s28, s35
    s_addc_u32 s49, s29, 0
    s_waitcnt lgkmcnt(0)
    s_mul_i32 s34, s34, 1664525
    s_add_u32 s34, s34, 1013904223
    s_barrier
    global_load_dwordx4 v[64:67], v3, s[40:41] offset:0 nt
    global_load_dwordx4 v[68:71], v3, s[40:41] offset:1024 nt
    global_load_dwordx4 v[72:75], v3, s[40:41] offset:2048 nt
    global_load_dwordx4 v[76:79], v3, s[40:41] offset:3072 nt
    s_load_dwordx16 s[8:23], s[58:59], 0 glc
    s_load_dwordx16 s[64:79], s[58:59], 64 glc
    s_load_dwordx16 s[80:95], s[58:59], 128 glc
    global_load_dwordx4 v[80:83], v3, s[42:43] offset:0 nt
    global_load_dwordx4 v[84:87], v3, s[42:43] offset:1024 nt
    global_load_dwordx4 v[88:91], v3, s[42:43] offset:2048 nt
    global_load_dwordx4 v[92:95], v3, s[42:43] offset:3072 nt
L_sq_1:
    s_waitcnt lgkmcnt(0)
    s_cmp_lg_u32 s11, s34
    s_cbranch_scc1 L_sqr_2
    s_cmp_lg_u32 s15, s34
    s_cbranch_scc1 L_sqr_2
    s_cmp_lg_u32 s19, s34
    s_cbranch_scc1 L_sqr_2
    s_cmp_lg_u32 s23, s34
    s_cbranch_scc1 L_sqr_2
    s_cmp_lg_u32 s67, s34
    s_cbranch_scc1 L_sqr_2
    s_cmp_lg_u32 s71, s34
    s_cbranch_scc1 L_sqr_2
    s_cmp_lg_u32 s75, s34
    s_cbranch_scc1 L_sqr_2
    s_cmp_lg_u32 s79, s34
    s_cbranch_scc1 L_sqr_2
    s_cmp_lg_u32 s83, s34
    s_cbranch_scc1 L_sqr_2
    s_cmp_lg_u32 s87, s34
    s_cbranch_scc1 L_sqr_2
    s_cmp_lg_u32 s91, s34
    s_cbranch_scc1 L_sqr_2
    s_branch L_sqd_3
L_sqr_2:
    s_load_dwordx16 s[8:23], s[58:59], 0 glc
    s_load_dwordx16 s[64:79], s[58:59], 64 glc
    s_load_dwordx16 s[80:95], s[58:59], 128 glc
    s_add_u32 s44, s44, 1
    s_cmp_gt_u32 s44, 0x40000
    s_cbranch_scc0 L_sq_1
    s_waitcnt lgkmcnt(0)
L_sqd_3:
    v_writelane_b32 v8, s8, 0
    v_writelane_b32 v8, s9, 1
    v_writelane_b32 v8, s10, 2
    v_writelane_b32 v8, s12, 3
    v_writelane_b32 v8, s13, 4
    v_writelane_b32 v8, s14, 5
    v_writelane_b32 v8, s16, 6
    v_writelane_b32 v8, s17, 7
    v_writelane_b32 v8, s18, 8
    v_writelane_b32 v8, s20, 9
    v_writelane_b32 v8, s21, 10
    v_writelane_b32 v8, s22, 11
    v_writelane_b32 v8, s64, 12
    v_writelane_b32 v8, s65, 13
    v_writelane_b32 v8, s66, 14
    v_writelane_b32 v8, s68, 15
    v_writelane_b32 v8, s69, 16
    v_writelane_b32 v8, s70, 17
    v_writelane_b32 v8, s72, 18
    v_writelane_b32 v8, s73, 19
    v_writelane_b32 v8, s74, 20
    v_writelane_b32 v8, s76, 21
    v_writelane_b32 v8, s77, 22
    v_writelane_b32 v8, s78, 23
    v_writelane_b32 v8, s80, 24
    v_writelane_b32 v8, s81, 25
    v_writelane_b32 v8, s82, 26
    v_writelane_b32 v8, s84, 27
    v_writelane_b32 v8, s85, 28
    v_writelane_b32 v8, s86, 29
    v_writelane_b32 v8, s88, 30
    v_writelane_b32 v8, s89, 31
    s_mov_b32 exec_hi, 0
    ds_write_b32 v19, v8
    s_mov_b32 exec_hi, -1
    s_waitcnt lgkmcnt(0)
    s_barrier
    ds_read_b128 v[96:99], v4 offset:0
    ds_read_b128 v[100:103], v4 offset:128
    ds_read_b128 v[104:107], v4 offset:256
    ds_read_b128 v[108:111], v4 offset:384
    ds_read_b128 v[112:115], v5 offset:0
    ds_read_b128 v[116:119], v5 offset:128
    ds_read_b128 v[120:123], v5 offset:256
    ds_read_b128 v[124:127], v5 offset:384
    s_waitcnt vmcnt(8) lgkmcnt(0)
    v_mfma_f32_16x16x32_bf16 v[8:11], v[96:99], v[32:35], 0
    v_mfma_f32_16x16x32_bf16 v[8:11], v[100:103], v[36:39], v[8:11]
    v_mfma_f32_16x16x32_bf16 v[8:11], v[104:107], v[40:43], v[8:11]
    v_mfma_f32_16x16x32_bf16 v[8:11], v[108:111], v[44:47], v[8:11]
    v_mfma_f32_16x16x32_bf16 v[8:11], v[112:115], v[48:51], v[8:11]
    v_mfma_f32_16x16x32_bf16 v[8:11], v[116:119], v[52:55], v[8:11]
    v_mfma_f32_16x16x32_bf16 v[8:11], v[120:123], v[56:59], v[8:11]
    v_mfma_f32_16x16x32_bf16 v[8:11], v[124:127], v[60:63], v[8:11]
    s_nop 7
    v_add_f32_dpp v12, v10, v8 row_ror:8 row_mask:0xf bank_mask:0xf
    v_add_f32_dpp v13, v11, v9 row_ror:8 row_mask:0xf bank_mask:0xf
    s_nop 1
    v_permlane32_swap_b32 v12, v13
    v_cvt_pk_bf16_f32 v12, v12, v12
    v_lshlrev_b32 v12, 16, v12
    v_cndmask_b32 v12, v15, v12, s[46:47]
    s_nop 1
    v_max_f32_dpp v16, v12, v12 quad_perm:[1,0,3,2] row_mask:0xf bank_mask:0xf
    s_nop 1
    v_max_f32_dpp v16, v16, v16 quad_perm:[2,3,0,1] row_mask:0xf bank_mask:0xf
    s_nop 1
    v_max_f32_dpp v16, v16, v16 row_half_mirror row_mask:0xf bank_mask:0xf
    s_nop 1
    v_max_f32_dpp v16, v16, v16 row_mirror row_mask:0xf bank_mask:0xf
    s_nop 1
    v_max_f32_dpp v16, v16, v16 row_bcast:15 row_mask:0xa bank_mask:0xf
    s_mov_b32 exec_lo, 0x10000
    s_mov_b32 exec_hi, 0x10000
    ds_write_b32 v28, v16 offset:1792
    s_mov_b64 exec, -1
    s_waitcnt lgkmcnt(0)
    s_barrier
    ds_read_b128 v[112:115], v29 offset:1792
    ds_read_b128 v[116:119], v29 offset:1808
    s_waitcnt lgkmcnt(0)
    v_max3_f32 v112, v112, v113, v114
    v_max3_f32 v115, v115, v116, v117
    v_max3_f32 v112, v112, v118, v119
    v_max_f32 v112, v112, v115
    v_sub_f32 v12, v12, v112
    v_mul_f32 v12, 0x3db8aa3b, v12
    v_exp_f32 v12, v12
    s_nop 1
    v_mov_b32_dpp v14, v12 quad_perm:[2,3,0,1] row_mask:0xf bank_mask:0xf
    v_cvt_pk_bf16_f32 v14, v12, v14
    ds_bpermute_b32 v48, v31, v14 offset:0
    ds_bpermute_b32 v52, v31, v14 offset:128
    ds_bpermute_b32 v49, v31, v14 offset:16
    ds_bpermute_b32 v53, v31, v14 offset:144
    ds_bpermute_b32 v50, v31, v14 offset:64
    ds_bpermute_b32 v54, v31, v14 offset:192
    ds_bpermute_b32 v51, v31, v14 offset:80
    ds_bpermute_b32 v55, v31, v14 offset:208
    v_add_f32_dpp v16, v12, v12 quad_perm:[1,0,3,2] row_mask:0xf bank_mask:0xf
    s_nop 1
    v_add_f32_dpp v16, v16, v16 quad_perm:[2,3,0,1] row_mask:0xf bank_mask:0xf
    s_nop 1
    v_add_f32_dpp v16, v16, v16 row_half_mirror row_mask:0xf bank_mask:0xf
    s_nop 1
    v_add_f32_dpp v16, v16, v16 row_mirror row_mask:0xf bank_mask:0xf
    s_nop 1
    v_add_f32_dpp v16, v16, v16 row_bcast:15 row_mask:0xa bank_mask:0xf
    s_mov_b32 exec_lo, 0x10000
    s_mov_b32 exec_hi, 0x10000
    ds_write_b32 v28, v16 offset:1856
    s_mov_b64 exec, -1
    s_waitcnt lgkmcnt(0)
    s_waitcnt vmcnt(6)
    v_perm_b32 v112, v68, v64, s32
    v_perm_b32 v113, v68, v64, s33
    v_perm_b32 v114, v69, v65, s32
    v_perm_b32 v115, v69, v65, s33
    v_perm_b32 v116, v70, v66, s32
    v_perm_b32 v117, v70, v66, s33
    v_perm_b32 v118, v71, v67, s32
    v_perm_b32 v119, v71, v67, s33
    v_dot2_f32_bf16 v32, v112, v48, 0
    v_dot2_f32_bf16 v33, v113, v48, 0
    v_dot2_f32_bf16 v34, v114, v48, 0
    v_dot2_f32_bf16 v35, v115, v48, 0
    v_dot2_f32_bf16 v36, v116, v48, 0
    v_dot2_f32_bf16 v37, v117, v48, 0
    v_dot2_f32_bf16 v38, v118, v48, 0
    v_dot2_f32_bf16 v39, v119, v48, 0
    v_dot2_f32_bf16 v40, v112, v52, 0
    v_dot2_f32_bf16 v41, v113, v52, 0
    v_dot2_f32_bf16 v42, v114, v52, 0
    v_dot2_f32_bf16 v43, v115, v52, 0
    v_dot2_f32_bf16 v44, v116, v52, 0
    v_dot2_f32_bf16 v45, v117, v52, 0
    v_dot2_f32_bf16 v46, v118, v52, 0
    v_dot2_f32_bf16 v47, v119, v52, 0
    s_waitcnt vmcnt(4)
    v_perm_b32 v120, v76, v72, s32
    v_perm_b32 v121, v76, v72, s33
    v_perm_b32 v122, v77, v73, s32
    v_perm_b32 v123, v77, v73, s33
    v_perm_b32 v124, v78, v74, s32
    v_perm_b32 v125, v78, v74, s33
    v_perm_b32 v126, v79, v75, s32
    v_perm_b32 v127, v79, v75, s33
    v_dot2_f32_bf16 v32, v120, v49, v32
    v_dot2_f32_bf16 v33, v121, v49, v33
    v_dot2_f32_bf16 v34, v122, v49, v34
    v_dot2_f32_bf16 v35, v123, v49, v35
    v_dot2_f32_bf16 v36, v124, v49, v36
    v_dot2_f32_bf16 v37, v125, v49, v37
    v_dot2_f32_bf16 v38, v126, v49, v38
    v_dot2_f32_bf16 v39, v127, v49, v39
    v_dot2_f32_bf16 v40, v120, v53, v40
    v_dot2_f32_bf16 v41, v121, v53, v41
    v_dot2_f32_bf16 v42, v122, v53, v42
    v_dot2_f32_bf16 v43, v123, v53, v43
    v_dot2_f32_bf16 v44, v124, v53, v44
    v_dot2_f32_bf16 v45, v125, v53, v45
    v_dot2_f32_bf16 v46, v126, v53, v46
    v_dot2_f32_bf16 v47, v127, v53, v47
    s_waitcnt vmcnt(2)
    v_perm_b32 v112, v84, v80, s32
    v_perm_b32 v113, v84, v80, s33
    v_perm_b32 v114, v85, v81, s32
    v_perm_b32 v115, v85, v81, s33
    v_perm_b32 v116, v86, v82, s32
    v_perm_b32 v117, v86, v82, s33
    v_perm_b32 v118, v87, v83, s32
    v_perm_b32 v119, v87, v83, s33
    v_dot2_f32_bf16 v32, v112, v50, v32
    v_dot2_f32_bf16 v33, v113, v50, v33
    v_dot2_f32_bf16 v34, v114, v50, v34
    v_dot2_f32_bf16 v35, v115, v50, v35
    v_dot2_f32_bf16 v36, v116, v50, v36
    v_dot2_f32_bf16 v37, v117, v50, v37
    v_dot2_f32_bf16 v38, v118, v50, v38
    v_dot2_f32_bf16 v39, v119, v50, v39
    v_dot2_f32_bf16 v40, v112, v54, v40
    v_dot2_f32_bf16 v41, v113, v54, v41
    v_dot2_f32_bf16 v42, v114, v54, v42
    v_dot2_f32_bf16 v43, v115, v54, v43
    v_dot2_f32_bf16 v44, v116, v54, v44
    v_dot2_f32_bf16 v45, v117, v54, v45
    v_dot2_f32_bf16 v46, v118, v54, v46
    v_dot2_f32_bf16 v47, v119, v54, v47
    s_waitcnt vmcnt(0)
    v_perm_b32 v120, v92, v88, s32
    v_perm_b32 v121, v92, v88, s33
    v_perm_b32 v122, v93, v89, s32
    v_perm_b32 v123, v93, v89, s33
    v_perm_b32 v124, v94, v90, s32
    v_perm_b32 v125, v94, v90, s33
    v_perm_b32 v126, v95, v91, s32
    v_perm_b32 v127, v95, v91, s33
    v_dot2_f32_bf16 v32, v120, v51, v32
    v_dot2_f32_bf16 v33, v121, v51, v33
    v_dot2_f32_bf16 v34, v122, v51, v34
    v_dot2_f32_bf16 v35, v123, v51, v35
    v_dot2_f32_bf16 v36, v124, v51, v36
    v_dot2_f32_bf16 v37, v125, v51, v37
    v_dot2_f32_bf16 v38, v126, v51, v38
    v_dot2_f32_bf16 v39, v127, v51, v39
    v_dot2_f32_bf16 v40, v120, v55, v40
    v_dot2_f32_bf16 v41, v121, v55, v41
    v_dot2_f32_bf16 v42, v122, v55, v42
    v_dot2_f32_bf16 v43, v123, v55, v43
    v_dot2_f32_bf16 v44, v124, v55, v44
    v_dot2_f32_bf16 v45, v125, v55, v45
    v_dot2_f32_bf16 v46, v126, v55, v46
    v_dot2_f32_bf16 v47, v127, v55, v47
    v_permlane32_swap_b32 v32, v40
    v_permlane32_swap_b32 v33, v41
    v_permlane32_swap_b32 v34, v42
    v_permlane32_swap_b32 v35, v43
    v_permlane32_swap_b32 v36, v44
    v_permlane32_swap_b32 v37, v45
    v_permlane32_swap_b32 v38, v46
    v_permlane32_swap_b32 v39, v47
    v_add_f32 v32, v32, v40
    v_add_f32 v33, v33, v41
    v_add_f32 v34, v34, v42
    v_add_f32 v35, v35, v43
    v_add_f32 v36, v36, v44
    v_add_f32 v37, v37, v45
    v_add_f32 v38, v38, v46
    v_add_f32 v39, v39, v47
    ds_write_b128 v30, v[32:35] offset:6144
    ds_write_b128 v30, v[36:39] offset:6160
    s_waitcnt lgkmcnt(0)
    s_barrier
    ds_read2st64_b32 v[8:9], v17 offset0:24 offset1:32
    ds_read2st64_b32 v[10:11], v17 offset0:40 offset1:48
    ds_read2st64_b32 v[12:13], v17 offset0:56 offset1:64
    ds_read_b32 v14, v17 offset:18432
    s_waitcnt lgkmcnt(0)
    v_add_f32 v8, v8, v9
    v_add_f32 v10, v10, v11
    v_add_f32 v12, v12, v13
    v_add_f32 v8, v8, v10
    v_add_f32 v12, v12, v14
    v_add_f32 v8, v8, v12
    v_min_u32 v8, -2, v8
    s_add_u32 s58, s56, 4194304
    s_addc_u32 s59, s57, 0
    global_store_dword v17, v8, s[58:59]
    global_store_dword v17, v8, s[56:57] sc1
    s_cmp_lt_u32 s31, 2
    s_cbranch_scc0 L_fin
    s_cmp_lt_u32 s30, 7
    s_cbranch_scc0 L_fin
    v_lshlrev_b32 v3, 4, v0
    v_and_b32 v24, 15, v0
    v_lshlrev_b32 v24, 2, v24
    v_and_b32 v25, 7, v0
    v_lshlrev_b32 v25, 4, v25
    v_lshrrev_b32 v26, 4, v0
    v_lshl_add_u32 v25, v26, 2, v25
    s_lshl_b32 s35, s3, 7
    v_add_u32 v25, s35, v25
L_lt_4:
    global_load_dword v48, v24, s[48:49] sc1
    s_waitcnt vmcnt(0)
    v_cmp_ne_u32 vcc, s34, v48
    s_cbranch_vccz L_ld_5
    s_add_u32 s44, s44, 1
    s_cmp_gt_u32 s44, 0x40000
    s_cbranch_scc0 L_lt_4
L_ld_5:
L_pl_6:
    global_load_dwordx4 v[40:43], v3, s[52:53] sc1
    global_load_dwordx4 v[44:47], v3, s[52:53] offset:1024 sc1
    s_waitcnt vmcnt(0)
    v_max3_u32 v50, v40, v41, v42
    v_max3_u32 v51, v43, v44, v45
    v_max3_u32 v50, v50, v46, v47
    v_max_u32 v50, v50, v51
    v_cmp_eq_u32 vcc, -1, v50
    s_cbranch_vccz L_pd_7
    s_mov_b64 exec, vcc
    s_add_u32 s44, s44, 1
    s_cmp_gt_u32 s44, 0x40000
    s_cbranch_scc0 L_pl_6
L_pd_7:
    s_mov_b64 exec, -1
    v_add_f32 v40, v40, v44
    v_add_f32 v41, v41, v45
    v_add_f32 v42, v42, v46
    v_add_f32 v43, v43, v47
    s_nop 0
    v_permlane32_swap_b32 v40, v42
    v_permlane32_swap_b32 v41, v43
    v_add_f32 v40, v40, v42
    v_add_f32 v41, v41, v43
    s_nop 1
    v_permlane16_swap_b32 v40, v41
    v_add_f32 v40, v40, v41
    s_nop 1
    v_add_f32_dpp v40, v40, v40 row_ror:8 row_mask:0xf bank_mask:0xf
    ds_write_b32 v25, v40 offset:3968
    s_waitcnt lgkmcnt(0)
    s_barrier
    s_branch L_fin
L_Yq:
L_Ym:
L_Ys:
    s_sub_u32 s46, s31, 16
    s_lshr_b32 s47, s46, 3
    s_mul_i32 s48, s47, 224
    s_lshl_b32 s45, s3, 5
    s_add_u32 s48, s48, s45
    s_lshl_b32 s35, s48, 13
    s_lshl_b32 s45, s30, 10
    s_add_u32 s35, s35, s45
    s_and_b32 s45, s46, 7
    s_lshl_b32 s45, s45, 7
    s_add_u32 s35, s35, s45
    v_lshrrev_b32 v6, 3, v0
    v_lshlrev_b32 v9, 3, v6
    v_lshlrev_b32 v6, 15, v6
    v_and_b32 v7, 7, v0
    v_lshl_add_u32 v6, v7, 4, v6
    s_waitcnt lgkmcnt(0)
    s_add_u32 s36, s10, s35
    s_addc_u32 s37, s11, 0
    s_barrier
    global_load_dwordx4 v[96:99], v6, s[36:37] nt
    s_add_u32 s36, s36, 8192
    s_addc_u32 s37, s37, 0
    global_load_dwordx4 v[100:103], v6, s[36:37] nt
    s_add_u32 s36, s36, 8192
    s_addc_u32 s37, s37, 0
    global_load_dwordx4 v[104:107], v6, s[36:37] nt
    s_add_u32 s36, s36, 8192
    s_addc_u32 s37, s37, 0
    global_load_dwordx4 v[108:111], v6, s[36:37] nt
    s_load_dword s34, s[28:29], 0
    s_lshl_b32 s35, s48, 1
    v_add_u32 v9, s35, v9
    v_and_b32 v7, 7, v0
    v_lshlrev_b32 v7, 5, v7
    v_lshrrev_b32 v8, 4, v0
    v_lshl_add_u32 v7, v8, 3, v7
    s_lshl_b32 s35, s3, 8
    v_add_u32 v7, s35, v7
    v_and_b32 v2, 7, v0
    v_lshlrev_b32 v2, 9, v2
    v_lshrrev_b32 v3, 3, v0
    v_lshl_add_u32 v2, v3, 4, v2
    v_lshlrev_b32 v3, 4, v0
    s_and_b32 s35, s46, 7
    s_lshl_b32 s35, s35, 1
    s_min_u32 s45, s3, 1
    s_add_u32 s35, s35, s45
    s_add_u32 s35, s35, 112
    s_lshl_b32 s35, s35, 13
    s_lshl_b32 s45, s30, 22
    s_add_u32 s35, s35, s45
    s_add_u32 s35, s35, 0x300000
    s_add_u32 s36, s6, s35
    s_addc_u32 s37, s7, 0
    s_add_u32 s38, s36, 4096
    s_addc_u32 s39, s37, 0
    s_add_u32 s40, s8, s35
    s_addc_u32 s41, s9, 0
    s_add_u32 s42, s40, 4096
    s_addc_u32 s43, s41, 0
    s_mov_b64 s[6:7], s[12:13]
    s_lshl_b32 s35, s30, 5
    s_add_u32 s35, s35, s31
    s_mul_i32 s35, s35, 2176
    s_add_u32 s45, s35, 524288
    s_add_u32 s56, s28, s45
    s_addc_u32 s57, s29, 0
    s_add_u32 s35, s35, 1540096
    s_mul_i32 s45, s3, 192
    s_add_u32 s35, s35, s45
    s_add_u32 s58, s28, s35
    s_addc_u32 s59, s29, 0
    s_lshr_b32 s35, s3, 2
    s_mul_i32 s35, s35, 640
    s_and_b32 s45, s3, 3
    s_lshl_b32 s45, s45, 7
    s_add_u32 s35, s35, s45
    v_lshl_add_u32 v19, v0, 2, s35
    s_lshl_b32 s35, s3, 8
    v_lshl_add_u32 v17, v0, 2, s35
    s_waitcnt lgkmcnt(0)
    s_mul_i32 s34, s34, 1664525
    s_add_u32 s34, s34, 1013904223
    s_waitcnt lgkmcnt(0)
    s_barrier
    ds_read_b64 v[28:29], v9 offset:2048
    s_waitcnt vmcnt(2) lgkmcnt(0)
    v_perm_b32 v112, v100, v96, s32
    v_perm_b32 v113, v100, v96, s33
    v_perm_b32 v114, v101, v97, s32
    v_perm_b32 v115, v101, v97, s33
    v_perm_b32 v116, v102, v98, s32
    v_perm_b32 v117, v102, v98, s33
    v_perm_b32 v118, v103, v99, s32
    v_perm_b32 v119, v103, v99, s33
    v_dot2_f32_bf16 v20, v112, v28, 0
    v_dot2_f32_bf16 v21, v113, v28, 0
    v_dot2_f32_bf16 v22, v114, v28, 0
    v_dot2_f32_bf16 v23, v115, v28, 0
    v_dot2_f32_bf16 v24, v116, v28, 0
    v_dot2_f32_bf16 v25, v117, v28, 0
    v_dot2_f32_bf16 v26, v118, v28, 0
    v_dot2_f32_bf16 v27, v119, v28, 0
    s_waitcnt vmcnt(0) lgkmcnt(0)
    v_perm_b32 v120, v108, v104, s32
    v_perm_b32 v121, v108, v104, s33
    v_perm_b32 v122, v109, v105, s32
    v_perm_b32 v123, v109, v105, s33
    v_perm_b32 v124, v110, v106, s32
    v_perm_b32 v125, v110, v106, s33
    v_perm_b32 v126, v111, v107, s32
    v_perm_b32 v127, v111, v107, s33
    v_dot2_f32_bf16 v20, v120, v29, v20
    v_dot2_f32_bf16 v21, v121, v29, v21
    v_dot2_f32_bf16 v22, v122, v29, v22
    v_dot2_f32_bf16 v23, v123, v29, v23
    v_dot2_f32_bf16 v24, v124, v29, v24
    v_dot2_f32_bf16 v25, v125, v29, v25
    v_dot2_f32_bf16 v26, v126, v29, v26
    v_dot2_f32_bf16 v27, v127, v29, v27
    v_permlane32_swap_b32 v20, v24
    v_permlane32_swap_b32 v21, v25
    v_permlane32_swap_b32 v22, v26
    v_permlane32_swap_b32 v23, v27
    v_add_f32 v20, v20, v24
    v_add_f32 v21, v21, v25
    v_add_f32 v22, v22, v26
    v_add_f32 v23, v23, v27
    s_nop 0
    v_permlane16_swap_b32 v20, v22
    v_permlane16_swap_b32 v21, v23
    v_add_f32 v20, v20, v22
    v_add_f32 v21, v21, v23
    s_nop 0
    v_add_f32_dpp v20, v20, v20 row_ror:8 row_mask:0xf bank_mask:0xf
    v_add_f32_dpp v21, v21, v21 row_ror:8 row_mask:0xf bank_mask:0xf
    ds_write_b64 v7, v[20:21] offset:3968
    s_waitcnt lgkmcnt(0)
    s_barrier
    s_cmp_lt_u32 s31, 24
    s_cbranch_scc0 L_Ym2
    s_cmp_lt_u32 s3, 2
    s_cbranch_scc0 L_Yq_notile
    v_and_b32 v6, 1, v0
    v_mul_u32_u24 v6, 640, v6
    v_lshrrev_b32 v7, 4, v0
    v_lshlrev_b32 v7, 5, v7
    v_bfe_u32 v8, v0, 1, 1
    v_lshl_add_u32 v7, v8, 4, v7
    v_add_u32 v6, v6, v7
    v_add_u32 v7, 1280, v7
    v_bfe_u32 v8, v0, 2, 2
    v_cmp_eq_u32 vcc, 0, v8
    s_nop 1
    v_cndmask_b32 v4, v7, v6, vcc
    v_cmp_eq_u32 vcc, 1, v8
    s_nop 1
    v_cndmask_b32 v5, v7, v6, vcc
    v_mov_b32 v15, 0xff800000
    s_mov_b32 s46, 0x00ff00ff
    s_mov_b32 s47, 0x00ff00ff
    v_lshrrev_b32 v31, 5, v0
    v_lshlrev_b32 v29, 5, v31
    s_lshl_b32 s35, s3, 2
    v_add_u32 v28, s35, v29
    v_lshlrev_b32 v31, 2, v31
    s_lshl_b32 s35, s3, 11
    v_lshl_add_u32 v30, v0, 5, s35
    s_barrier
    global_load_dwordx4 v[32:35], v2, s[36:37] offset:0 nt
    global_load_dwordx4 v[36:39], v2, s[36:37] offset:128 nt
    global_load_dwordx4 v[40:43], v2, s[36:37] offset:256 nt
    global_load_dwordx4 v[44:47], v2, s[36:37] offset:384 nt
    global_load_dwordx4 v[48:51], v2, s[38:39] offset:0 nt
    global_load_dwordx4 v[52:55], v2, s[38:39] offset:128 nt
    global_load_dwordx4 v[56:59], v2, s[38:39] offset:256 nt
    global_load_dwordx4 v[60:63], v2, s[38:39] offset:384 nt
    global_load_dwordx4 v[64:67], v3, s[40:41] offset:0 nt
    global_load_dwordx4 v[68:71], v3, s[40:41] offset:1024 nt
    global_load_dwordx4 v[72:75], v3, s[40:41] offset:2048 nt
    global_load_dwordx4 v[76:79], v3, s[40:41] offset:3072 nt
    global_load_dwordx4 v[80:83], v3, s[42:43] offset:0 nt
    global_load_dwordx4 v[84:87], v3, s[42:43] offset:1024 nt
    global_load_dwordx4 v[88:91], v3, s[42:43] offset:2048 nt
    global_load_dwordx4 v[92:95], v3, s[42:43] offset:3072 nt
    s_load_dwordx16 s[8:23], s[58:59], 0 glc
    s_load_dwordx16 s[64:79], s[58:59], 64 glc
    s_load_dwordx16 s[80:95], s[58:59], 128 glc
L_sq_8:
    s_waitcnt lgkmcnt(0)
    s_cmp_lg_u32 s11, s34
    s_cbranch_scc1 L_sqr_9
    s_cmp_lg_u32 s15, s34
    s_cbranch_scc1 L_sqr_9
    s_cmp_lg_u32 s19, s34
    s_cbranch_scc1 L_sqr_9
    s_cmp_lg_u32 s23, s34
    s_cbranch_scc1 L_sqr_9
    s_cmp_lg_u32 s67, s34
    s_cbranch_scc1 L_sqr_9
    s_cmp_lg_u32 s71, s34
    s_cbranch_scc1 L_sqr_9
    s_cmp_lg_u32 s75, s34
    s_cbranch_scc1 L_sqr_9
    s_cmp_lg_u32 s79, s34
    s_cbranch_scc1 L_sqr_9
    s_cmp_lg_u32 s83, s34
    s_cbranch_scc1 L_sqr_9
    s_cmp_lg_u32 s87, s34
    s_cbranch_scc1 L_sqr_9
    s_cmp_lg_u32 s91, s34
    s_cbranch_scc1 L_sqr_9
    s_branch L_sqd_10
L_sqr_9:
    s_load_dwordx16 s[8:23], s[58:59], 0 glc
    s_load_dwordx16 s[64:79], s[58:59], 64 glc
    s_load_dwordx16 s[80:95], s[58:59], 128 glc
    s_add_u32 s44, s44, 1
    s_cmp_gt_u32 s44, 0x40000
    s_cbranch_scc0 L_sq_8
    s_waitcnt lgkmcnt(0)
L_sqd_10:
    v_writelane_b32 v8, s8, 0
    v_writelane_b32 v8, s9, 1
    v_writelane_b32 v8, s10, 2
    v_writelane_b32 v8, s12, 3
    v_writelane_b32 v8, s13, 4
    v_writelane_b32 v8, s14, 5
    v_writelane_b32 v8, s16, 6
    v_writelane_b32 v8, s17, 7
    v_writelane_b32 v8, s18, 8
    v_writelane_b32 v8, s20, 9
    v_writelane_b32 v8, s21, 10
    v_writelane_b32 v8, s22, 11
    v_writelane_b32 v8, s64, 12
    v_writelane_b32 v8, s65, 13
    v_writelane_b32 v8, s66, 14
    v_writelane_b32 v8, s68, 15
    v_writelane_b32 v8, s69, 16
    v_writelane_b32 v8, s70, 17
    v_writelane_b32 v8, s72, 18
    v_writelane_b32 v8, s73, 19
    v_writelane_b32 v8, s74, 20
    v_writelane_b32 v8, s76, 21
    v_writelane_b32 v8, s77, 22
    v_writelane_b32 v8, s78, 23
    v_writelane_b32 v8, s80, 24
    v_writelane_b32 v8, s81, 25
    v_writelane_b32 v8, s82, 26
    v_writelane_b32 v8, s84, 27
    v_writelane_b32 v8, s85, 28
    v_writelane_b32 v8, s86, 29
    v_writelane_b32 v8, s88, 30
    v_writelane_b32 v8, s89, 31
    s_mov_b32 exec_hi, 0
    ds_write_b32 v19, v8
    s_mov_b32 exec_hi, -1
    s_waitcnt lgkmcnt(0)
    s_barrier
    ds_read_b128 v[96:99], v4 offset:0
    ds_read_b128 v[100:103], v4 offset:128
    ds_read_b128 v[104:107], v4 offset:256
    ds_read_b128 v[108:111], v4 offset:384
    ds_read_b128 v[112:115], v5 offset:0
    ds_read_b128 v[116:119], v5 offset:128
    ds_read_b128 v[120:123], v5 offset:256
    ds_read_b128 v[124:127], v5 offset:384
    s_waitcnt vmcnt(8) lgkmcnt(0)
    v_mfma_f32_16x16x32_bf16 v[8:11], v[96:99], v[32:35], 0
    v_mfma_f32_16x16x32_bf16 v[8:11], v[100:103], v[36:39], v[8:11]
    v_mfma_f32_16x16x32_bf16 v[8:11], v[104:107], v[40:43], v[8:11]
    v_mfma_f32_16x16x32_bf16 v[8:11], v[108:111], v[44:47], v[8:11]
    v_mfma_f32_16x16x32_bf16 v[8:11], v[112:115], v[48:51], v[8:11]
    v_mfma_f32_16x16x32_bf16 v[8:11], v[116:119], v[52:55], v[8:11]
    v_mfma_f32_16x16x32_bf16 v[8:11], v[120:123], v[56:59], v[8:11]
    v_mfma_f32_16x16x32_bf16 v[8:11], v[124:127], v[60:63], v[8:11]
    s_lshl_b32 s48, s30, 9
    s_sub_u32 s49, s31, 16
    s_lshl_b32 s49, s49, 6
    s_add_u32 s48, s48, s49
    s_mul_i32 s35, s48, 896
    s_lshl_b32 s45, s3, 7
    s_add_u32 s35, s35, s45
    s_add_u32 s38, s6, s35
    s_addc_u32 s39, s7, 0
    s_add_u32 s60, s38, 3584
    s_addc_u32 s61, s39, 0
    v_lshrrev_b32 v6, 3, v0
    v_mul_u32_u24 v6, 7168, v6
    v_and_b32 v7, 7, v0
    v_lshl_add_u32 v6, v7, 4, v6
    global_load_dwordx4 v[96:99], v6, s[38:39] offset:0 nt
    global_load_dwordx4 v[100:103], v6, s[38:39] offset:896 nt
    global_load_dwordx4 v[104:107], v6, s[38:39] offset:1792 nt
    global_load_dwordx4 v[108:111], v6, s[38:39] offset:2688 nt
    global_load_dwordx4 v[112:115], v6, s[60:61] offset:0 nt
    global_load_dwordx4 v[116:119], v6, s[60:61] offset:896 nt
    global_load_dwordx4 v[120:123], v6, s[60:61] offset:1792 nt
    global_load_dwordx4 v[124:127], v6, s[60:61] offset:2688 nt
    v_add_f32_dpp v12, v10, v8 row_ror:8 row_mask:0xf bank_mask:0xf
    v_add_f32_dpp v13, v11, v9 row_ror:8 row_mask:0xf bank_mask:0xf
    s_nop 1
    v_permlane32_swap_b32 v12, v13
    v_cvt_pk_bf16_f32 v12, v12, v12
    v_lshlrev_b32 v12, 16, v12
    v_cndmask_b32 v12, v15, v12, s[46:47]
    s_nop 1
    v_max_f32_dpp v16, v12, v12 quad_perm:[1,0,3,2] row_mask:0xf bank_mask:0xf
    s_nop 1
    v_max_f32_dpp v16, v16, v16 quad_perm:[2,3,0,1] row_mask:0xf bank_mask:0xf
    s_nop 1
    v_max_f32_dpp v16, v16, v16 row_half_mirror row_mask:0xf bank_mask:0xf
    s_nop 1
    v_max_f32_dpp v16, v16, v16 row_mirror row_mask:0xf bank_mask:0xf
    s_nop 1
    v_max_f32_dpp v16, v16, v16 row_bcast:15 row_mask:0xa bank_mask:0xf
    s_mov_b32 exec_lo, 0x10000
    s_mov_b32 exec_hi, 0x10000
    ds_write_b32 v28, v16 offset:1792
    s_mov_b64 exec, -1
    s_waitcnt lgkmcnt(0)
    s_barrier
    ds_read_b128 v[56:59], v29 offset:1792
    ds_read_b128 v[60:63], v29 offset:1808
    s_waitcnt lgkmcnt(0)
    v_max3_f32 v56, v56, v57, v58
    v_max3_f32 v59, v59, v60, v61
    v_max3_f32 v56, v56, v62, v63
    v_max_f32 v56, v56, v59
    v_sub_f32 v12, v12, v56
    v_mul_f32 v12, 0x3db8aa3b, v12
    v_exp_f32 v12, v12
    s_nop 1
    v_mov_b32_dpp v14, v12 quad_perm:[2,3,0,1] row_mask:0xf bank_mask:0xf
    v_cvt_pk_bf16_f32 v14, v12, v14
    ds_bpermute_b32 v48, v31, v14 offset:0
    ds_bpermute_b32 v52, v31, v14 offset:128
    ds_bpermute_b32 v49, v31, v14 offset:16
    ds_bpermute_b32 v53, v31, v14 offset:144
    ds_bpermute_b32 v50, v31, v14 offset:64
    ds_bpermute_b32 v54, v31, v14 offset:192
    ds_bpermute_b32 v51, v31, v14 offset:80
    ds_bpermute_b32 v55, v31, v14 offset:208
    v_add_f32_dpp v16, v12, v12 quad_perm:[1,0,3,2] row_mask:0xf bank_mask:0xf
    s_nop 1
    v_add_f32_dpp v16, v16, v16 quad_perm:[2,3,0,1] row_mask:0xf bank_mask:0xf
    s_nop 1
    v_add_f32_dpp v16, v16, v16 row_half_mirror row_mask:0xf bank_mask:0xf
    s_nop 1
    v_add_f32_dpp v16, v16, v16 row_mirror row_mask:0xf bank_mask:0xf
    s_nop 1
    v_add_f32_dpp v16, v16, v16 row_bcast:15 row_mask:0xa bank_mask:0xf
    s_mov_b32 exec_lo, 0x10000
    s_mov_b32 exec_hi, 0x10000
    ds_write_b32 v28, v16 offset:1856
    s_mov_b64 exec, -1
    s_waitcnt lgkmcnt(0)
    s_waitcnt vmcnt(14)
    v_perm_b32 v56, v68, v64, s32
    v_perm_b32 v57, v68, v64, s33
    v_perm_b32 v58, v69, v65, s32
    v_perm_b32 v59, v69, v65, s33
    v_perm_b32 v60, v70, v66, s32
    v_perm_b32 v61, v70, v66, s33
    v_perm_b32 v62, v71, v67, s32
    v_perm_b32 v63, v71, v67, s33
    v_dot2_f32_bf16 v32, v56, v48, 0
    v_dot2_f32_bf16 v33, v57, v48, 0
    v_dot2_f32_bf16 v34, v58, v48, 0
    v_dot2_f32_bf16 v35, v59, v48, 0
    v_dot2_f32_bf16 v36, v60, v48, 0
    v_dot2_f32_bf16 v37, v61, v48, 0
    v_dot2_f32_bf16 v38, v62, v48, 0
    v_dot2_f32_bf16 v39, v63, v48, 0
    v_dot2_f32_bf16 v40, v56, v52, 0
    v_dot2_f32_bf16 v41, v57, v52, 0
    v_dot2_f32_bf16 v42, v58, v52, 0
    v_dot2_f32_bf16 v43, v59, v52, 0
    v_dot2_f32_bf16 v44, v60, v52, 0
    v_dot2_f32_bf16 v45, v61, v52, 0
    v_dot2_f32_bf16 v46, v62, v52, 0
    v_dot2_f32_bf16 v47, v63, v52, 0
    s_waitcnt vmcnt(12)
    v_perm_b32 v56, v76, v72, s32
    v_perm_b32 v57, v76, v72, s33
    v_perm_b32 v58, v77, v73, s32
    v_perm_b32 v59, v77, v73, s33
    v_perm_b32 v60, v78, v74, s32
    v_perm_b32 v61, v78, v74, s33
    v_perm_b32 v62, v79, v75, s32
    v_perm_b32 v63, v79, v75, s33
    v_dot2_f32_bf16 v32, v56, v49, v32
    v_dot2_f32_bf16 v33, v57, v49, v33
    v_dot2_f32_bf16 v34, v58, v49, v34
    v_dot2_f32_bf16 v35, v59, v49, v35
    v_dot2_f32_bf16 v36, v60, v49, v36
    v_dot2_f32_bf16 v37, v61, v49, v37
    v_dot2_f32_bf16 v38, v62, v49, v38
    v_dot2_f32_bf16 v39, v63, v49, v39
    v_dot2_f32_bf16 v40, v56, v53, v40
    v_dot2_f32_bf16 v41, v57, v53, v41
    v_dot2_f32_bf16 v42, v58, v53, v42
    v_dot2_f32_bf16 v43, v59, v53, v43
    v_dot2_f32_bf16 v44, v60, v53, v44
    v_dot2_f32_bf16 v45, v61, v53, v45
    v_dot2_f32_bf16 v46, v62, v53, v46
    v_dot2_f32_bf16 v47, v63, v53, v47
    s_waitcnt vmcnt(10)
    v_perm_b32 v56, v84, v80, s32
    v_perm_b32 v57, v84, v80, s33
    v_perm_b32 v58, v85, v81, s32
    v_perm_b32 v59, v85, v81, s33
    v_perm_b32 v60, v86, v82, s32
    v_perm_b32 v61, v86, v82, s33
    v_perm_b32 v62, v87, v83, s32
    v_perm_b32 v63, v87, v83, s33
    v_dot2_f32_bf16 v32, v56, v50, v32
    v_dot2_f32_bf16 v33, v57, v50, v33
    v_dot2_f32_bf16 v34, v58, v50, v34
    v_dot2_f32_bf16 v35, v59, v50, v35
    v_dot2_f32_bf16 v36, v60, v50, v36
    v_dot2_f32_bf16 v37, v61, v50, v37
    v_dot2_f32_bf16 v38, v62, v50, v38
    v_dot2_f32_bf16 v39, v63, v50, v39
    v_dot2_f32_bf16 v40, v56, v54, v40
    v_dot2_f32_bf16 v41, v57, v54, v41
    v_dot2_f32_bf16 v42, v58, v54, v42
    v_dot2_f32_bf16 v43, v59, v54, v43
    v_dot2_f32_bf16 v44, v60, v54, v44
    v_dot2_f32_bf16 v45, v61, v54, v45
    v_dot2_f32_bf16 v46, v62, v54, v46
    v_dot2_f32_bf16 v47, v63, v54, v47
    s_waitcnt vmcnt(8)
    v_perm_b32 v56, v92, v88, s32
    v_perm_b32 v57, v92, v88, s33
    v_perm_b32 v58, v93, v89, s32
    v_perm_b32 v59, v93, v89, s33
    v_perm_b32 v60, v94, v90, s32
    v_perm_b32 v61, v94, v90, s33
    v_perm_b32 v62, v95, v91, s32
    v_perm_b32 v63, v95, v91, s33
    v_dot2_f32_bf16 v32, v56, v51, v32
    v_dot2_f32_bf16 v33, v57, v51, v33
    v_dot2_f32_bf16 v34, v58, v51, v34
    v_dot2_f32_bf16 v35, v59, v51, v35
    v_dot2_f32_bf16 v36, v60, v51, v36
    v_dot2_f32_bf16 v37, v61, v51, v37
    v_dot2_f32_bf16 v38, v62, v51, v38
    v_dot2_f32_bf16 v39, v63, v51, v39
    v_dot2_f32_bf16 v40, v56, v55, v40
    v_dot2_f32_bf16 v41, v57, v55, v41
    v_dot2_f32_bf16 v42, v58, v55, v42
    v_dot2_f32_bf16 v43, v59, v55, v43
    v_dot2_f32_bf16 v44, v60, v55, v44
    v_dot2_f32_bf16 v45, v61, v55, v45
    v_dot2_f32_bf16 v46, v62, v55, v46
    v_dot2_f32_bf16 v47, v63, v55, v47
    v_permlane32_swap_b32 v32, v40
    v_permlane32_swap_b32 v33, v41
    v_permlane32_swap_b32 v34, v42
    v_permlane32_swap_b32 v35, v43
    v_permlane32_swap_b32 v36, v44
    v_permlane32_swap_b32 v37, v45
    v_permlane32_swap_b32 v38, v46
    v_permlane32_swap_b32 v39, v47
    v_add_f32 v32, v32, v40
    v_add_f32 v33, v33, v41
    v_add_f32 v34, v34, v42
    v_add_f32 v35, v35, v43
    v_add_f32 v36, v36, v44
    v_add_f32 v37, v37, v45
    v_add_f32 v38, v38, v46
    v_add_f32 v39, v39, v47
    ds_write_b128 v30, v[32:35] offset:6144
    ds_write_b128 v30, v[36:39] offset:6160
    s_branch L_Yq_comb
L_Yq_notile:
    s_barrier
    s_load_dwordx16 s[8:23], s[58:59], 0 glc
    s_load_dwordx16 s[64:79], s[58:59], 64 glc
    s_load_dwordx16 s[80:95], s[58:59], 128 glc
L_sq_11:
    s_waitcnt lgkmcnt(0)
    s_cmp_lg_u32 s11, s34
    s_cbranch_scc1 L_sqr_12
    s_cmp_lg_u32 s15, s34
    s_cbranch_scc1 L_sqr_12
    s_cmp_lg_u32 s19, s34
    s_cbranch_scc1 L_sqr_12
    s_cmp_lg_u32 s23, s34
    s_cbranch_scc1 L_sqr_12
    s_cmp_lg_u32 s67, s34
    s_cbranch_scc1 L_sqr_12
    s_cmp_lg_u32 s71, s34
    s_cbranch_scc1 L_sqr_12
    s_cmp_lg_u32 s75, s34
    s_cbranch_scc1 L_sqr_12
    s_cmp_lg_u32 s79, s34
    s_cbranch_scc1 L_sqr_12
    s_cmp_lg_u32 s83, s34
    s_cbranch_scc1 L_sqr_12
    s_cmp_lg_u32 s87, s34
    s_cbranch_scc1 L_sqr_12
    s_cmp_lg_u32 s91, s34
    s_cbranch_scc1 L_sqr_12
    s_branch L_sqd_13
L_sqr_12:
    s_load_dwordx16 s[8:23], s[58:59], 0 glc
    s_load_dwordx16 s[64:79], s[58:59], 64 glc
    s_load_dwordx16 s[80:95], s[58:59], 128 glc
    s_add_u32 s44, s44, 1
    s_cmp_gt_u32 s44, 0x40000
    s_cbranch_scc0 L_sq_11
    s_waitcnt lgkmcnt(0)
L_sqd_13:
    v_writelane_b32 v8, s8, 0
    v_writelane_b32 v8, s9, 1
    v_writelane_b32 v8, s10, 2
    v_writelane_b32 v8, s12, 3
    v_writelane_b32 v8, s13, 4
    v_writelane_b32 v8, s14, 5
    v_writelane_b32 v8, s16, 6
    v_writelane_b32 v8, s17, 7
    v_writelane_b32 v8, s18, 8
    v_writelane_b32 v8, s20, 9
    v_writelane_b32 v8, s21, 10
    v_writelane_b32 v8, s22, 11
    v_writelane_b32 v8, s64, 12
    v_writelane_b32 v8, s65, 13
    v_writelane_b32 v8, s66, 14
    v_writelane_b32 v8, s68, 15
    v_writelane_b32 v8, s69, 16
    v_writelane_b32 v8, s70, 17
    v_writelane_b32 v8, s72, 18
    v_writelane_b32 v8, s73, 19
    v_writelane_b32 v8, s74, 20
    v_writelane_b32 v8, s76, 21
    v_writelane_b32 v8, s77, 22
    v_writelane_b32 v8, s78, 23
    v_writelane_b32 v8, s80, 24
    v_writelane_b32 v8, s81, 25
    v_writelane_b32 v8, s82, 26
    v_writelane_b32 v8, s84, 27
    v_writelane_b32 v8, s85, 28
    v_writelane_b32 v8, s86, 29
    v_writelane_b32 v8, s88, 30
    v_writelane_b32 v8, s89, 31
    s_mov_b32 exec_hi, 0
    ds_write_b32 v19, v8
    s_mov_b32 exec_hi, -1
    s_waitcnt lgkmcnt(0)
    s_barrier
    s_lshl_b32 s48, s30, 9
    s_sub_u32 s49, s31, 16
    s_lshl_b32 s49, s49, 6
    s_add_u32 s48, s48, s49
    s_mul_i32 s35, s48, 896
    s_lshl_b32 s45, s3, 7
    s_add_u32 s35, s35, s45
    s_add_u32 s38, s6, s35
    s_addc_u32 s39, s7, 0
    s_add_u32 s60, s38, 3584
    s_addc_u32 s61, s39, 0
    v_lshrrev_b32 v6, 3, v0
    v_mul_u32_u24 v6, 7168, v6
    v_and_b32 v7, 7, v0
    v_lshl_add_u32 v6, v7, 4, v6
    global_load_dwordx4 v[96:99], v6, s[38:39] offset:0 nt
    global_load_dwordx4 v[100:103], v6, s[38:39] offset:896 nt
    global_load_dwordx4 v[104:107], v6, s[38:39] offset:1792 nt
    global_load_dwordx4 v[108:111], v6, s[38:39] offset:2688 nt
    global_load_dwordx4 v[112:115], v6, s[60:61] offset:0 nt
    global_load_dwordx4 v[116:119], v6, s[60:61] offset:896 nt
    global_load_dwordx4 v[120:123], v6, s[60:61] offset:1792 nt
    global_load_dwordx4 v[124:127], v6, s[60:61] offset:2688 nt
    s_waitcnt lgkmcnt(0)
    s_barrier
L_Yq_comb:
    s_waitcnt lgkmcnt(0)
    s_barrier
    ds_read2st64_b32 v[8:9], v17 offset0:24 offset1:32
    s_waitcnt lgkmcnt(0)
    v_add_f32 v8, v8, v9
    v_min_u32 v8, -2, v8
    s_add_u32 s58, s56, 4194304
    s_addc_u32 s59, s57, 0
    global_store_dword v17, v8, s[58:59]
    global_store_dword v17, v8, s[56:57] sc1
    s_waitcnt vmcnt(0)
    v_perm_b32 v32, v100, v96, s32
    v_perm_b32 v33, v100, v96, s33
    v_perm_b32 v34, v101, v97, s32
    v_perm_b32 v35, v101, v97, s33
    v_perm_b32 v36, v102, v98, s32
    v_perm_b32 v37, v102, v98, s33
    v_perm_b32 v38, v103, v99, s32
    v_perm_b32 v39, v103, v99, s33
    v_perm_b32 v40, v108, v104, s32
    v_perm_b32 v41, v108, v104, s33
    v_perm_b32 v42, v109, v105, s32
    v_perm_b32 v43, v109, v105, s33
    v_perm_b32 v44, v110, v106, s32
    v_perm_b32 v45, v110, v106, s33
    v_perm_b32 v46, v111, v107, s32
    v_perm_b32 v47, v111, v107, s33
    v_perm_b32 v48, v116, v112, s32
    v_perm_b32 v49, v116, v112, s33
    v_perm_b32 v50, v117, v113, s32
    v_perm_b32 v51, v117, v113, s33
    v_perm_b32 v52, v118, v114, s32
    v_perm_b32 v53, v118, v114, s33
    v_perm_b32 v54, v119, v115, s32
    v_perm_b32 v55, v119, v115, s33
    v_perm_b32 v56, v124, v120, s32
    v_perm_b32 v57, v124, v120, s33
    v_perm_b32 v58, v125, v121, s32
    v_perm_b32 v59, v125, v121, s33
    v_perm_b32 v60, v126, v122, s32
    v_perm_b32 v61, v126, v122, s33
    v_perm_b32 v62, v127, v123, s32
    v_perm_b32 v63, v127, v123, s33
    s_lshl_b32 s35, s30, 4
    s_add_u32 s35, s35, s31
    s_sub_u32 s35, s35, 16
    s_lshl_b32 s35, s35, 7
    s_lshl_b32 s45, s3, 15
    s_add_u32 s35, s35, s45
    s_add_u32 s35, s35, 1310720
    s_add_u32 s36, s28, s35
    s_addc_u32 s37, s29, 0
    v_bfe_u32 v6, v0, 2, 1
    v_lshlrev_b32 v6, 14, v6
    v_and_b32 v7, 3, v0
    v_lshl_add_u32 v6, v7, 5, v6
    v_lshrrev_b32 v7, 4, v0
    v_lshl_add_u32 v6, v7, 3, v6
    v_lshrrev_b32 v8, 3, v0
    v_lshlrev_b32 v8, 4, v8
    s_waitcnt lgkmcnt(0)
    s_barrier
    ds_read_b128 v[12:15], v8 offset:1920
    s_waitcnt lgkmcnt(0)
    v_dot2_f32_bf16 v20, v32, v12, 0
    v_dot2_f32_bf16 v21, v33, v12, 0
    v_dot2_f32_bf16 v22, v34, v12, 0
    v_dot2_f32_bf16 v23, v35, v12, 0
    v_dot2_f32_bf16 v24, v36, v12, 0
    v_dot2_f32_bf16 v25, v37, v12, 0
    v_dot2_f32_bf16 v26, v38, v12, 0
    v_dot2_f32_bf16 v27, v39, v12, 0
    v_dot2_f32_bf16 v20, v40, v13, v20
    v_dot2_f32_bf16 v21, v41, v13, v21
    v_dot2_f32_bf16 v22, v42, v13, v22
    v_dot2_f32_bf16 v23, v43, v13, v23
    v_dot2_f32_bf16 v24, v44, v13, v24
    v_dot2_f32_bf16 v25, v45, v13, v25
    v_dot2_f32_bf16 v26, v46, v13, v26
    v_dot2_f32_bf16 v27, v47, v13, v27
    v_dot2_f32_bf16 v20, v48, v14, v20
    v_dot2_f32_bf16 v21, v49, v14, v21
    v_dot2_f32_bf16 v22, v50, v14, v22
    v_dot2_f32_bf16 v23, v51, v14, v23
    v_dot2_f32_bf16 v24, v52, v14, v24
    v_dot2_f32_bf16 v25, v53, v14, v25
    v_dot2_f32_bf16 v26, v54, v14, v26
    v_dot2_f32_bf16 v27, v55, v14, v27
    v_dot2_f32_bf16 v20, v56, v15, v20
    v_dot2_f32_bf16 v21, v57, v15, v21
    v_dot2_f32_bf16 v22, v58, v15, v22
    v_dot2_f32_bf16 v23, v59, v15, v23
    v_dot2_f32_bf16 v24, v60, v15, v24
    v_dot2_f32_bf16 v25, v61, v15, v25
    v_dot2_f32_bf16 v26, v62, v15, v26
    v_dot2_f32_bf16 v27, v63, v15, v27
    v_permlane32_swap_b32 v20, v24
    v_permlane32_swap_b32 v21, v25
    v_permlane32_swap_b32 v22, v26
    v_permlane32_swap_b32 v23, v27
    v_add_f32 v20, v20, v24
    v_add_f32 v21, v21, v25
    v_add_f32 v22, v22, v26
    v_add_f32 v23, v23, v27
    s_nop 0
    v_permlane16_swap_b32 v20, v22
    v_permlane16_swap_b32 v21, v23
    v_add_f32 v20, v20, v22
    v_add_f32 v21, v21, v23
    s_nop 0
    v_add_f32_dpp v20, v20, v20 row_ror:8 row_mask:0xf bank_mask:0xf
    v_add_f32_dpp v21, v21, v21 row_ror:8 row_mask:0xf bank_mask:0xf
    v_min_u32 v20, -2, v20
    v_min_u32 v21, -2, v21
    s_mov_b32 exec_lo, 0x00ff00ff
    s_mov_b32 exec_hi, 0x00ff00ff
    global_store_dwordx2 v6, v[20:21], s[36:37] sc1
    s_mov_b64 exec, -1
    s_branch L_fin
L_Ym2:
    s_cmp_eq_u32 s31, 31
    s_cbranch_scc1 L_fin
    s_mul_i32 s46, s30, 7
    s_add_u32 s46, s46, s31
    s_sub_u32 s46, s46, 24
    s_mul_i32 s35, s3, 229376
    s_lshl_b32 s45, s46, 6
    s_add_u32 s35, s35, s45
    v_lshrrev_b32 v10, 2, v0
    v_mul_u32_u24 v10, 14336, v10
    v_and_b32 v7, 3, v0
    v_lshl_add_u32 v10, v7, 4, v10
    s_add_u32 s36, s16, s35
    s_addc_u32 s37, s17, 0
    v_lshrrev_b32 v9, 2, v0
    v_lshlrev_b32 v9, 3, v9
    s_lshl_b32 s35, s3, 7
    v_add_u32 v9, s35, v9
    v_and_b32 v7, 3, v0
    v_lshlrev_b32 v7, 5, v7
    v_lshrrev_b32 v8, 4, v0
    v_lshl_add_u32 v7, v8, 3, v7
    v_add_u32 v12, s35, v7
    s_waitcnt lgkmcnt(0)
    s_barrier
    global_load_dwordx4 v[64:67], v10, s[36:37] offset:0 nt
    global_load_dwordx4 v[68:71], v10, s[36:37] offset:3584 nt
    s_add_u32 s36, s36, 7168
    s_addc_u32 s37, s37, 0
    global_load_dwordx4 v[72:75], v10, s[36:37] offset:0 nt
    global_load_dwordx4 v[76:79], v10, s[36:37] offset:3584 nt
    ds_read_b64 v[28:29], v9 offset:2944
    s_barrier
    s_lshl_b32 s46, s46, 5
    s_mul_i32 s35, s46, 896
    s_lshl_b32 s45, s3, 7
    s_add_u32 s35, s35, s45
    s_add_u32 s38, s20, s35
    s_addc_u32 s39, s21, 0
    v_lshrrev_b32 v6, 3, v0
    v_mul_u32_u24 v6, 3584, v6
    v_and_b32 v7, 7, v0
    v_lshl_add_u32 v6, v7, 4, v6
    global_load_dwordx4 v[32:35], v6, s[38:39] offset:0 nt
    global_load_dwordx4 v[36:39], v6, s[38:39] offset:896 nt
    global_load_dwordx4 v[40:43], v6, s[38:39] offset:1792 nt
    global_load_dwordx4 v[44:47], v6, s[38:39] offset:2688 nt
    s_waitcnt vmcnt(6) lgkmcnt(0)
    v_perm_b32 v96, v68, v64, s32
    v_perm_b32 v97, v68, v64, s33
    v_perm_b32 v98, v69, v65, s32
    v_perm_b32 v99, v69, v65, s33
    v_perm_b32 v100, v70, v66, s32
    v_perm_b32 v101, v70, v66, s33
    v_perm_b32 v102, v71, v67, s32
    v_perm_b32 v103, v71, v67, s33
    v_dot2_f32_bf16 v20, v96, v28, 0
    v_dot2_f32_bf16 v21, v97, v28, 0
    v_dot2_f32_bf16 v22, v98, v28, 0
    v_dot2_f32_bf16 v23, v99, v28, 0
    v_dot2_f32_bf16 v24, v100, v28, 0
    v_dot2_f32_bf16 v25, v101, v28, 0
    v_dot2_f32_bf16 v26, v102, v28, 0
    v_dot2_f32_bf16 v27, v103, v28, 0
    s_waitcnt vmcnt(4) lgkmcnt(0)
    v_perm_b32 v104, v76, v72, s32
    v_perm_b32 v105, v76, v72, s33
    v_perm_b32 v106, v77, v73, s32
    v_perm_b32 v107, v77, v73, s33
    v_perm_b32 v108, v78, v74, s32
    v_perm_b32 v109, v78, v74, s33
    v_perm_b32 v110, v79, v75, s32
    v_perm_b32 v111, v79, v75, s33
    v_dot2_f32_bf16 v20, v104, v29, v20
    v_dot2_f32_bf16 v21, v105, v29, v21
    v_dot2_f32_bf16 v22, v106, v29, v22
    v_dot2_f32_bf16 v23, v107, v29, v23
    v_dot2_f32_bf16 v24, v108, v29, v24
    v_dot2_f32_bf16 v25, v109, v29, v25
    v_dot2_f32_bf16 v26, v110, v29, v26
    v_dot2_f32_bf16 v27, v111, v29, v27
    v_permlane32_swap_b32 v20, v24
    v_permlane32_swap_b32 v21, v25
    v_permlane32_swap_b32 v22, v26
    v_permlane32_swap_b32 v23, v27
    v_add_f32 v20, v20, v24
    v_add_f32 v21, v21, v25
    v_add_f32 v22, v22, v26
    v_add_f32 v23, v23, v27
    s_nop 0
    v_permlane16_swap_b32 v20, v22
    v_permlane16_swap_b32 v21, v23
    v_add_f32 v20, v20, v22
    v_add_f32 v21, v21, v23
    s_nop 0
    v_add_f32_dpp v20, v20, v20 row_ror:8 row_mask:0xf bank_mask:0xf
    v_add_f32_dpp v21, v21, v21 row_ror:8 row_mask:0xf bank_mask:0xf
    s_nop 0
    v_add_f32_dpp v20, v20, v20 row_ror:4 row_mask:0xf bank_mask:0xf
    v_add_f32_dpp v21, v21, v21 row_ror:4 row_mask:0xf bank_mask:0xf
    ds_write_b64 v12, v[20:21] offset:3968
    v_lshrrev_b32 v8, 3, v0
    v_lshlrev_b32 v8, 3, v8
    s_waitcnt lgkmcnt(0)
    s_barrier
    s_waitcnt vmcnt(0)
    v_perm_b32 v112, v36, v32, s32
    v_perm_b32 v113, v36, v32, s33
    v_perm_b32 v114, v37, v33, s32
    v_perm_b32 v115, v37, v33, s33
    v_perm_b32 v116, v38, v34, s32
    v_perm_b32 v117, v38, v34, s33
    v_perm_b32 v118, v39, v35, s32
    v_perm_b32 v119, v39, v35, s33
    v_perm_b32 v120, v44, v40, s32
    v_perm_b32 v121, v44, v40, s33
    v_perm_b32 v122, v45, v41, s32
    v_perm_b32 v123, v45, v41, s33
    v_perm_b32 v124, v46, v42, s32
    v_perm_b32 v125, v46, v42, s33
    v_perm_b32 v126, v47, v43, s32
    v_perm_b32 v127, v47, v43, s33
    s_lshl_b32 s35, s30, 4
    s_add_u32 s35, s35, s31
    s_sub_u32 s35, s35, 16
    s_lshl_b32 s35, s35, 7
    s_lshl_b32 s45, s3, 15
    s_add_u32 s35, s35, s45
    s_add_u32 s35, s35, 1310720
    s_add_u32 s36, s28, s35
    s_addc_u32 s37, s29, 0
    v_bfe_u32 v6, v0, 2, 1
    v_lshlrev_b32 v6, 14, v6
    v_and_b32 v7, 3, v0
    v_lshl_add_u32 v6, v7, 5, v6
    v_lshrrev_b32 v7, 4, v0
    v_lshl_add_u32 v6, v7, 3, v6
    s_waitcnt lgkmcnt(0)
    s_barrier
    ds_read_b64 v[10:11], v8 offset:3840
    s_waitcnt lgkmcnt(0)
    v_dot2_f32_bf16 v20, v112, v10, 0
    v_dot2_f32_bf16 v21, v113, v10, 0
    v_dot2_f32_bf16 v22, v114, v10, 0
    v_dot2_f32_bf16 v23, v115, v10, 0
    v_dot2_f32_bf16 v24, v116, v10, 0
    v_dot2_f32_bf16 v25, v117, v10, 0
    v_dot2_f32_bf16 v26, v118, v10, 0
    v_dot2_f32_bf16 v27, v119, v10, 0
    v_dot2_f32_bf16 v20, v120, v11, v20
    v_dot2_f32_bf16 v21, v121, v11, v21
    v_dot2_f32_bf16 v22, v122, v11, v22
    v_dot2_f32_bf16 v23, v123, v11, v23
    v_dot2_f32_bf16 v24, v124, v11, v24
    v_dot2_f32_bf16 v25, v125, v11, v25
    v_dot2_f32_bf16 v26, v126, v11, v26
    v_dot2_f32_bf16 v27, v127, v11, v27
    v_permlane32_swap_b32 v20, v24
    v_permlane32_swap_b32 v21, v25
    v_permlane32_swap_b32 v22, v26
    v_permlane32_swap_b32 v23, v27
    v_add_f32 v20, v20, v24
    v_add_f32 v21, v21, v25
    v_add_f32 v22, v22, v26
    v_add_f32 v23, v23, v27
    s_nop 0
    v_permlane16_swap_b32 v20, v22
    v_permlane16_swap_b32 v21, v23
    v_add_f32 v20, v20, v22
    v_add_f32 v21, v21, v23
    s_nop 0
    v_add_f32_dpp v20, v20, v20 row_ror:8 row_mask:0xf bank_mask:0xf
    v_add_f32_dpp v21, v21, v21 row_ror:8 row_mask:0xf bank_mask:0xf
    v_min_u32 v20, -2, v20
    v_min_u32 v21, -2, v21
    s_mov_b32 exec_lo, 0x00ff00ff
    s_mov_b32 exec_hi, 0x00ff00ff
    global_store_dwordx2 v6, v[20:21], s[36:37] sc1
    s_mov_b64 exec, -1
    s_branch L_fin
L_service:
    v_lshlrev_b32 v2, 4, v0
    v_mov_b32 v3, 0
    v_mov_b32 v4, -1
    v_mov_b32 v5, -1
    v_mov_b32 v6, -1
    v_mov_b32 v7, -1
    v_mov_b32 v8, 0
    v_mov_b32 v9, 0
    v_mov_b32 v10, 0
    v_mov_b32 v11, 0
    s_waitcnt lgkmcnt(0)
    s_cmp_lt_u32 s31, 16
    s_cbranch_scc1 L_sv_nox
    s_mov_b32 exec_hi, 0x00ffffff
    global_load_dwordx4 v[8:11], v2, s[4:5]
    s_mov_b32 exec_hi, -1
    s_barrier
L_sv_nox:
    s_load_dword s34, s[28:29], 0
    s_lshl_b32 s35, s30, 5
    s_add_u32 s35, s35, s31
    s_mul_i32 s35, s35, 2176
    s_add_u32 s45, s35, 524288
    s_add_u32 s56, s28, s45
    s_addc_u32 s57, s29, 0
    s_add_u32 s35, s35, 1540096
    s_mul_i32 s45, s3, 192
    s_add_u32 s35, s35, s45
    s_add_u32 s58, s28, s35
    s_addc_u32 s59, s29, 0
    s_lshr_b32 s35, s3, 2
    s_mul_i32 s35, s35, 640
    s_and_b32 s45, s3, 3
    s_lshl_b32 s45, s45, 7
    s_add_u32 s35, s35, s45
    v_lshl_add_u32 v19, v0, 2, s35
    s_lshl_b32 s35, s3, 8
    v_lshl_add_u32 v17, v0, 2, s35
    s_cmp_lt_u32 s31, 24
    s_cbranch_scc0 L_sv_noo
    global_store_dwordx4 v2, v[4:7], s[56:57] sc1
    global_store_dwordx4 v2, v[4:7], s[56:57] offset:1024 sc1
    s_add_u32 s36, s56, 4194304
    s_addc_u32 s37, s57, 0
    global_store_dwordx4 v2, v[4:7], s[36:37]
    global_store_dwordx4 v2, v[4:7], s[36:37] offset:1024
L_sv_noo:
    s_lshl_b32 s35, s30, 4
    s_add_u32 s35, s35, s31
    s_max_u32 s35, s35, 16
    s_sub_u32 s47, s35, 16
    s_cmp_lt_u32 s31, 16
    s_cbranch_scc1 L_sv_nof
    s_lshl_b32 s35, s47, 7
    s_add_u32 s35, s35, 1310720
    s_add_u32 s36, s28, s35
    s_addc_u32 s37, s29, 0
    s_add_u32 s38, s36, 131072
    s_addc_u32 s39, s37, 0
    v_lshrrev_b32 v13, 3, v0
    v_lshlrev_b32 v13, 14, v13
    v_and_b32 v14, 7, v0
    v_lshl_add_u32 v13, v14, 4, v13
    s_cmp_eq_u32 s31, 31
    s_cselect_b32 s35, 0, -1
    v_mov_b32 v4, s35
    v_mov_b32 v5, s35
    v_mov_b32 v6, s35
    v_mov_b32 v7, s35
    global_store_dwordx4 v13, v[4:7], s[36:37] sc1
    s_mov_b32 exec_hi, 0x0000ffff
    global_store_dwordx4 v13, v[4:7], s[38:39] sc1
    s_mov_b32 exec_hi, -1
L_sv_nof:
    v_lshlrev_b32 v13, 3, v0
    v_mov_b32 v14, 0
    v_mov_b32 v15, 0
    ds_write_b64 v13, v[14:15] offset:1280
    v_lshlrev_b32 v13, 2, v0
    v_mov_b32 v16, 0xff800000
    v_cmp_gt_u32 vcc, 16, v0
    s_nop 1
    v_cndmask_b32 v16, v14, v16, vcc
    s_mov_b32 exec_hi, 0
    ds_write_b32 v13, v16 offset:1792
    s_mov_b64 exec, -1
    s_lshl_b32 s35, s47, 2
    s_add_u32 s35, s35, 4096
    s_add_u32 s38, s28, s35
    s_addc_u32 s39, s29, 0
    s_lshl_b32 s35, s30, 7
    s_add_u32 s35, s35, 8192
    s_add_u32 s40, s28, s35
    s_addc_u32 s41, s29, 0
    s_lshl_b32 s35, s30, 10
    s_lshl_b32 s45, s31, 4
    s_add_u32 s35, s35, s45
    s_add_u32 s35, s35, 131072
    s_add_u32 s42, s28, s35
    s_addc_u32 s43, s29, 0
    v_and_b32 v36, 1, v0
    v_lshlrev_b32 v37, 9, v36
    v_lshlrev_b32 v36, 5, v36
    s_cmp_lt_u32 s31, 24
    s_cbranch_scc0 L_sv_nos
    s_add_u32 s36, s42, 4194304
    s_addc_u32 s37, s43, 0
    v_mov_b32 v4, -1
    v_mov_b32 v5, -1
    v_mov_b32 v6, -1
    v_mov_b32 v7, -1
    s_mov_b64 exec, 3
    global_store_dwordx4 v37, v[4:7], s[36:37]
    s_mov_b64 exec, -1
L_sv_nos:
    s_waitcnt lgkmcnt(0)
    s_mul_i32 s34, s34, 1664525
    s_add_u32 s34, s34, 1013904223
    s_cmp_lt_u32 s31, 16
    s_cbranch_scc1 L_svX
    s_branch L_svY
L_svX:
    s_min_u32 s35, s31, 1
    s_lshl_b32 s45, s30, 1
    s_add_u32 s45, s45, s35
    s_min_u32 s45, s45, 13
    v_and_b32 v20, 31, v0
    s_lshl_b32 s35, s45, 5
    v_add_u32 v20, s35, v20
    v_lshlrev_b32 v20, 1, v20
    s_lshl_b32 s35, s45, 14
    s_lshl_b32 s45, s3, 11
    s_add_u32 s35, s35, s45
    s_add_u32 s35, s35, 1310720
    s_add_u32 s52, s28, s35
    s_addc_u32 s53, s29, 0
    s_lshl_b32 s35, s3, 6
    s_add_u32 s35, s35, 4096
    s_add_u32 s48, s28, s35
    s_addc_u32 s49, s29, 0
    global_load_ushort v104, v20, s[4:5]
    global_load_ushort v105, v20, s[22:23]
    v_mov_b32 v106, v20
    s_mov_b64 s[6:7], s[24:25]
    s_barrier
    s_load_dwordx16 s[8:23], s[58:59], 0 glc
    s_load_dwordx16 s[64:79], s[58:59], 64 glc
    s_load_dwordx16 s[80:95], s[58:59], 128 glc
L_sq_14:
    s_waitcnt lgkmcnt(0)
    s_cmp_lg_u32 s11, s34
    s_cbranch_scc1 L_sqr_15
    s_cmp_lg_u32 s15, s34
    s_cbranch_scc1 L_sqr_15
    s_cmp_lg_u32 s19, s34
    s_cbranch_scc1 L_sqr_15
    s_cmp_lg_u32 s23, s34
    s_cbranch_scc1 L_sqr_15
    s_cmp_lg_u32 s67, s34
    s_cbranch_scc1 L_sqr_15
    s_cmp_lg_u32 s71, s34
    s_cbranch_scc1 L_sqr_15
    s_cmp_lg_u32 s75, s34
    s_cbranch_scc1 L_sqr_15
    s_cmp_lg_u32 s79, s34
    s_cbranch_scc1 L_sqr_15
    s_cmp_lg_u32 s83, s34
    s_cbranch_scc1 L_sqr_15
    s_cmp_lg_u32 s87, s34
    s_cbranch_scc1 L_sqr_15
    s_cmp_lg_u32 s91, s34
    s_cbranch_scc1 L_sqr_15
    s_branch L_sqd_16
L_sqr_15:
    s_load_dwordx16 s[8:23], s[58:59], 0 glc
    s_load_dwordx16 s[64:79], s[58:59], 64 glc
    s_load_dwordx16 s[80:95], s[58:59], 128 glc
    s_add_u32 s44, s44, 1
    s_cmp_gt_u32 s44, 0x40000
    s_cbranch_scc0 L_sq_14
    s_waitcnt lgkmcnt(0)
L_sqd_16:
    v_writelane_b32 v8, s8, 0
    v_writelane_b32 v8, s9, 1
    v_writelane_b32 v8, s10, 2
    v_writelane_b32 v8, s12, 3
    v_writelane_b32 v8, s13, 4
    v_writelane_b32 v8, s14, 5
    v_writelane_b32 v8, s16, 6
    v_writelane_b32 v8, s17, 7
    v_writelane_b32 v8, s18, 8
    v_writelane_b32 v8, s20, 9
    v_writelane_b32 v8, s21, 10
    v_writelane_b32 v8, s22, 11
    v_writelane_b32 v8, s64, 12
    v_writelane_b32 v8, s65, 13
    v_writelane_b32 v8, s66, 14
    v_writelane_b32 v8, s68, 15
    v_writelane_b32 v8, s69, 16
    v_writelane_b32 v8, s70, 17
    v_writelane_b32 v8, s72, 18
    v_writelane_b32 v8, s73, 19
    v_writelane_b32 v8, s74, 20
    v_writelane_b32 v8, s76, 21
    v_writelane_b32 v8, s77, 22
    v_writelane_b32 v8, s78, 23
    v_writelane_b32 v8, s80, 24
    v_writelane_b32 v8, s81, 25
    v_writelane_b32 v8, s82, 26
    v_writelane_b32 v8, s84, 27
    v_writelane_b32 v8, s85, 28
    v_writelane_b32 v8, s86, 29
    v_writelane_b32 v8, s88, 30
    v_writelane_b32 v8, s89, 31
    s_mov_b32 exec_hi, 0
    ds_write_b32 v19, v8
    s_mov_b32 exec_hi, -1
    s_waitcnt lgkmcnt(0)
    s_barrier
    s_waitcnt vmcnt(0)
    v_mov_b32 v14, s34
    s_lshl_b32 s35, s31, 2
    v_mov_b32 v13, s35
    s_getreg_b32 s35, hwreg(HW_REG_XCC_ID, 0, 4)
    s_add_u32 s35, s35, s34
    s_add_u32 s35, s35, 1
    v_mov_b32 v16, s35
    s_mov_b64 exec, 1
    global_store_dword v13, v16, s[40:41] sc1
    s_mov_b64 exec, -1
    s_waitcnt lgkmcnt(0)
    s_barrier
    s_waitcnt lgkmcnt(0)
    s_barrier
    ds_read2st64_b32 v[8:9], v17 offset0:24 offset1:32
    ds_read2st64_b32 v[10:11], v17 offset0:40 offset1:48
    ds_read2st64_b32 v[12:13], v17 offset0:56 offset1:64
    ds_read_b32 v14, v17 offset:18432
    s_waitcnt lgkmcnt(0)
    v_add_f32 v8, v8, v9
    v_add_f32 v10, v10, v11
    v_add_f32 v12, v12, v13
    v_add_f32 v8, v8, v10
    v_add_f32 v12, v12, v14
    v_add_f32 v8, v8, v12
    v_min_u32 v8, -2, v8
    s_add_u32 s58, s56, 4194304
    s_addc_u32 s59, s57, 0
    global_store_dword v17, v8, s[58:59]
    global_store_dword v17, v8, s[56:57] sc1
    ds_read_b128 v[20:23], v36 offset:1792
    ds_read_b128 v[24:27], v36 offset:1808
    ds_read_b128 v[28:31], v36 offset:1856
    ds_read_b128 v[32:35], v36 offset:1872
    s_waitcnt lgkmcnt(0)
    v_max3_f32 v40, v20, v21, v22
    v_max3_f32 v23, v23, v24, v25
    v_add_f32 v28, v28, v29
    v_add_f32 v30, v30, v31
    v_add_f32 v32, v32, v33
    v_add_f32 v34, v34, v35
    v_max3_f32 v40, v40, v26, v27
    v_add_f32 v28, v28, v30
    v_add_f32 v32, v32, v34
    v_max_f32 v40, v40, v23
    v_add_f32 v42, v28, v32
    v_mov_b32 v41, s34
    v_mov_b32 v43, s34
    s_mov_b64 exec, 3
    s_add_u32 s58, s42, 4194304
    s_addc_u32 s59, s43, 0
    global_store_dwordx4 v37, v[40:43], s[58:59]
    global_store_dwordx4 v37, v[40:43], s[42:43] sc1
    s_mov_b64 exec, -1
    s_cmp_lt_u32 s31, 2
    s_cbranch_scc0 L_fin
    s_cmp_lt_u32 s30, 7
    s_cbranch_scc0 L_fin
    v_lshlrev_b32 v3, 4, v0
    v_and_b32 v24, 15, v0
    v_lshlrev_b32 v24, 2, v24
    v_and_b32 v25, 7, v0
    v_lshlrev_b32 v25, 4, v25
    v_lshrrev_b32 v26, 4, v0
    v_lshl_add_u32 v25, v26, 2, v25
    s_lshl_b32 s35, s3, 7
    v_add_u32 v25, s35, v25
L_lt_17:
    global_load_dword v48, v24, s[48:49] sc1
    s_waitcnt vmcnt(0)
    v_cmp_ne_u32 vcc, s34, v48
    s_cbranch_vccz L_ld_18
    s_add_u32 s44, s44, 1
    s_cmp_gt_u32 s44, 0x40000
    s_cbranch_scc0 L_lt_17
L_ld_18:
L_pl_19:
    global_load_dwordx4 v[40:43], v3, s[52:53] sc1
    global_load_dwordx4 v[44:47], v3, s[52:53] offset:1024 sc1
    s_waitcnt vmcnt(0)
    v_max3_u32 v50, v40, v41, v42
    v_max3_u32 v51, v43, v44, v45
    v_max3_u32 v50, v50, v46, v47
    v_max_u32 v50, v50, v51
    v_cmp_eq_u32 vcc, -1, v50
    s_cbranch_vccz L_pd_20
    s_mov_b64 exec, vcc
    s_add_u32 s44, s44, 1
    s_cmp_gt_u32 s44, 0x40000
    s_cbranch_scc0 L_pl_19
L_pd_20:
    s_mov_b64 exec, -1
    v_add_f32 v40, v40, v44
    v_add_f32 v41, v41, v45
    v_add_f32 v42, v42, v46
    v_add_f32 v43, v43, v47
    s_nop 0
    v_permlane32_swap_b32 v40, v42
    v_permlane32_swap_b32 v41, v43
    v_add_f32 v40, v40, v42
    v_add_f32 v41, v41, v43
    s_nop 1
    v_permlane16_swap_b32 v40, v41
    v_add_f32 v40, v40, v41
    s_nop 1
    v_add_f32_dpp v40, v40, v40 row_ror:8 row_mask:0xf bank_mask:0xf
    ds_write_b32 v25, v40 offset:3968
    s_waitcnt lgkmcnt(0)
    s_barrier
    v_and_b32 v26, 31, v0
    v_lshlrev_b32 v26, 2, v26
    ds_read_b32 v80, v26 offset:3968
    ds_read_b32 v81, v26 offset:4096
    ds_read_b32 v82, v26 offset:4224
    ds_read_b32 v83, v26 offset:4352
    ds_read_b32 v84, v26 offset:4480
    ds_read_b32 v85, v26 offset:4608
    ds_read_b32 v86, v26 offset:4736
    ds_read_b32 v87, v26 offset:4864
    v_lshlrev_b32 v104, 16, v104
    v_lshlrev_b32 v105, 16, v105
    v_add_f32 v104, v104, v105
    s_waitcnt lgkmcnt(0)
    v_add_f32 v80, v80, v81
    v_add_f32 v82, v82, v83
    v_add_f32 v84, v84, v85
    v_add_f32 v86, v86, v87
    v_add_f32 v80, v80, v82
    v_add_f32 v84, v84, v86
    v_add_f32 v80, v80, v84
    v_add_f32 v80, v80, v104
    v_cvt_pk_bf16_f32 v80, v80, v80
    s_mov_b32 exec_hi, 0
    global_store_short v106, v80, s[6:7]
    s_mov_b64 exec, -1
    s_cmp_eq_u32 s2, 0
    s_cbranch_scc0 L_fin
    v_mov_b32 v14, s34
    v_mov_b32 v13, 0
    s_mov_b64 exec, 1
    global_store_dword v13, v14, s[28:29] sc1
    s_mov_b64 exec, -1
    s_branch L_fin
L_svY:
    s_mul_i32 s46, s30, 7
    s_max_u32 s47, s31, 24
    s_min_u32 s47, s47, 30
    s_add_u32 s46, s46, s47
    s_sub_u32 s46, s46, 24
    s_lshl_b32 s35, s46, 6
    v_and_b32 v13, 15, v0
    v_lshlrev_b32 v13, 2, v13
    v_add_u32 v13, s35, v13
    global_load_dword v44, v13, s[18:19]
    s_and_b32 s47, s31, 7
    s_lshl_b32 s35, s47, 9
    s_lshl_b32 s45, s30, 12
    s_add_u32 s35, s35, s45
    s_add_u32 s35, s35, 4206592
    s_add_u32 s46, s28, s35
    s_addc_u32 s47, s29, 0
    v_and_b32 v13, 31, v0
    v_lshlrev_b32 v13, 4, v13
    global_load_dword v46, v13, s[46:47] sc1
    s_cmp_lt_u32 s31, 24
    s_cbranch_scc1 L_svY_a
    s_waitcnt vmcnt(4)
    s_branch L_svY_b
L_svY_a:
    s_waitcnt vmcnt(9)
L_svY_b:
    v_lshlrev_b32 v20, 16, v8
    v_and_b32 v21, 0xffff0000, v8
    v_lshlrev_b32 v22, 16, v9
    v_and_b32 v23, 0xffff0000, v9
    v_lshlrev_b32 v24, 16, v10
    v_and_b32 v25, 0xffff0000, v10
    v_lshlrev_b32 v26, 16, v11
    v_and_b32 v27, 0xffff0000, v11
    v_add_f32 v28, v20, v21
    v_add_f32 v29, v22, v23
    v_add_f32 v30, v24, v25
    v_add_f32 v31, v26, v27
    v_add_f32 v28, v28, v29
    v_add_f32 v30, v30, v31
    v_add_f32 v28, v28, v30
    s_nop 1
    v_add_f32_dpp v28, v28, v28 quad_perm:[1,0,3,2] row_mask:0xf bank_mask:0xf
    s_nop 1
    v_add_f32_dpp v28, v28, v28 quad_perm:[2,3,0,1] row_mask:0xf bank_mask:0xf
    s_nop 1
    v_add_f32_dpp v28, v28, v28 row_half_mirror row_mask:0xf bank_mask:0xf
    s_nop 1
    v_add_f32_dpp v28, v28, v28 row_mirror row_mask:0xf bank_mask:0xf
    s_nop 1
    v_add_f32_dpp v28, v28, v28 row_bcast:15 row_mask:0xa bank_mask:0xf
    s_nop 1
    v_add_f32_dpp v28, v28, v28 row_bcast:31 row_mask:0xc bank_mask:0xf
    s_nop 0
    v_readlane_b32 s35, v28, 63
    v_mov_b32 v29, 0x3b124925
    s_nop 0
    v_mul_f32 v30, s35, v29
    v_mov_b32 v28, 0
    v_mov_b32 v33, 0
    s_mov_b32 exec_hi, 0x00ffffff
    v_sub_f32 v31, v20, v30
    v_sub_f32 v32, v21, v30
    v_fmac_f32 v28, v31, v31
    v_fmac_f32 v33, v32, v32
    v_sub_f32 v31, v22, v30
    v_sub_f32 v32, v23, v30
    v_fmac_f32 v28, v31, v31
    v_fmac_f32 v33, v32, v32
    v_sub_f32 v31, v24, v30
    v_sub_f32 v32, v25, v30
    v_fmac_f32 v28, v31, v31
    v_fmac_f32 v33, v32, v32
    v_sub_f32 v31, v26, v30
    v_sub_f32 v32, v27, v30
    v_fmac_f32 v28, v31, v31
    v_fmac_f32 v33, v32, v32
    s_mov_b32 exec_hi, -1
    v_add_f32 v28, v28, v33
    s_nop 1
    v_add_f32_dpp v28, v28, v28 quad_perm:[1,0,3,2] row_mask:0xf bank_mask:0xf
    s_nop 1
    v_add_f32_dpp v28, v28, v28 quad_perm:[2,3,0,1] row_mask:0xf bank_mask:0xf
    s_nop 1
    v_add_f32_dpp v28, v28, v28 row_half_mirror row_mask:0xf bank_mask:0xf
    s_nop 1
    v_add_f32_dpp v28, v28, v28 row_mirror row_mask:0xf bank_mask:0xf
    s_nop 1
    v_add_f32_dpp v28, v28, v28 row_bcast:15 row_mask:0xa bank_mask:0xf
    s_nop 1
    v_add_f32_dpp v28, v28, v28 row_bcast:31 row_mask:0xc bank_mask:0xf
    s_nop 0
    v_readlane_b32 s35, v28, 63
    s_nop 1
    v_mul_f32 v31, s35, v29
    v_cvt_pk_bf16_f32 v32, v30, v31
    v_lshlrev_b32 v30, 16, v32
    v_and_b32 v31, 0xffff0000, v32
    v_add_f32 v31, 0x3727c5ac, v31
    v_cvt_pk_bf16_f32 v31, v31, v31
    v_lshlrev_b32 v31, 16, v31
    v_sqrt_f32 v31, v31
    v_sub_f32 v20, v20, v30
    v_sub_f32 v21, v21, v30
    v_sub_f32 v22, v22, v30
    v_sub_f32 v23, v23, v30
    v_sub_f32 v24, v24, v30
    v_sub_f32 v25, v25, v30
    v_sub_f32 v26, v26, v30
    v_sub_f32 v27, v27, v30
    v_cvt_pk_bf16_f32 v31, v31, v31
    v_lshlrev_b32 v31, 16, v31
    v_rcp_f32 v32, v31
    v_cvt_pk_bf16_f32 v8, v20, v21
    v_cvt_pk_bf16_f32 v9, v22, v23
    v_cvt_pk_bf16_f32 v10, v24, v25
    v_cvt_pk_bf16_f32 v11, v26, v27
    v_lshlrev_b32 v20, 16, v8
    v_and_b32 v21, 0xffff0000, v8
    v_lshlrev_b32 v22, 16, v9
    v_and_b32 v23, 0xffff0000, v9
    v_lshlrev_b32 v24, 16, v10
    v_and_b32 v25, 0xffff0000, v10
    v_lshlrev_b32 v26, 16, v11
    v_and_b32 v27, 0xffff0000, v11
    v_mul_f32 v28, v20, v32
    v_fma_f32 v29, -v28, v31, v20
    v_fma_f32 v20, v29, v32, v28
    v_mul_f32 v28, v21, v32
    v_fma_f32 v29, -v28, v31, v21
    v_fma_f32 v21, v29, v32, v28
    v_mul_f32 v28, v22, v32
    v_fma_f32 v29, -v28, v31, v22
    v_fma_f32 v22, v29, v32, v28
    v_mul_f32 v28, v23, v32
    v_fma_f32 v29, -v28, v31, v23
    v_fma_f32 v23, v29, v32, v28
    v_mul_f32 v28, v24, v32
    v_fma_f32 v29, -v28, v31, v24
    v_fma_f32 v24, v29, v32, v28
    v_mul_f32 v28, v25, v32
    v_fma_f32 v29, -v28, v31, v25
    v_fma_f32 v25, v29, v32, v28
    v_mul_f32 v28, v26, v32
    v_fma_f32 v29, -v28, v31, v26
    v_fma_f32 v26, v29, v32, v28
    v_mul_f32 v28, v27, v32
    v_fma_f32 v29, -v28, v31, v27
    v_fma_f32 v27, v29, v32, v28
    v_cvt_pk_bf16_f32 v8, v20, v21
    v_cvt_pk_bf16_f32 v9, v22, v23
    v_cvt_pk_bf16_f32 v10, v24, v25
    v_cvt_pk_bf16_f32 v11, v26, v27
    s_mov_b32 exec_lo, 0
    s_mov_b32 exec_hi, 0xff000000
    v_mov_b32 v8, 0
    v_mov_b32 v9, 0
    v_mov_b32 v10, 0
    v_mov_b32 v11, 0
    s_mov_b64 exec, -1
    s_mov_b32 exec_hi, 0x00ffffff
    ds_write_b128 v2, v[8:11] offset:2048
    s_mov_b32 exec_hi, -1
    s_waitcnt lgkmcnt(0)
    s_barrier
    v_and_b32 v13, 31, v0
    v_lshlrev_b32 v45, 4, v13
    v_lshlrev_b32 v13, 3, v13
    s_sub_u32 s35, s31, 16
    s_and_b32 s47, s35, 7
    s_lshl_b32 s35, s47, 9
    s_lshl_b32 s45, s30, 12
    s_add_u32 s35, s35, s45
    s_add_u32 s35, s35, 12288
    s_add_u32 s54, s28, s35
    s_addc_u32 s55, s29, 0
    s_cmp_lt_u32 s31, 24
    s_cbranch_scc1 L_sv_send
    v_lshlrev_b32 v20, 16, v8
    v_and_b32 v21, 0xffff0000, v8
    v_lshlrev_b32 v22, 16, v9
    v_and_b32 v23, 0xffff0000, v9
    v_lshlrev_b32 v24, 16, v10
    v_and_b32 v25, 0xffff0000, v10
    v_lshlrev_b32 v26, 16, v11
    v_and_b32 v27, 0xffff0000, v11
    v_add_f32 v28, v20, v21
    v_add_f32 v29, v22, v23
    v_add_f32 v30, v24, v25
    v_add_f32 v31, v26, v27
    v_add_f32 v28, v28, v29
    v_add_f32 v30, v30, v31
    v_add_f32 v28, v28, v30
    s_nop 1
    v_add_f32_dpp v28, v28, v28 quad_perm:[1,0,3,2] row_mask:0xf bank_mask:0xf
    s_nop 1
    v_add_f32_dpp v28, v28, v28 quad_perm:[2,3,0,1] row_mask:0xf bank_mask:0xf
    s_nop 1
    v_add_f32_dpp v28, v28, v28 row_half_mirror row_mask:0xf bank_mask:0xf
    s_nop 1
    v_add_f32_dpp v28, v28, v28 row_mirror row_mask:0xf bank_mask:0xf
    s_nop 1
    v_add_f32_dpp v28, v28, v28 row_bcast:15 row_mask:0xa bank_mask:0xf
    s_nop 1
    v_add_f32_dpp v28, v28, v28 row_bcast:31 row_mask:0xc bank_mask:0xf
    s_nop 0
    v_readlane_b32 s35, v28, 63
    v_mov_b32 v29, 0x3b124925
    s_nop 0
    v_mul_f32 v30, s35, v29
    v_mov_b32 v28, 0
    v_mov_b32 v33, 0
    s_mov_b32 exec_hi, 0x00ffffff
    v_sub_f32 v31, v20, v30
    v_sub_f32 v32, v21, v30
    v_fmac_f32 v28, v31, v31
    v_fmac_f32 v33, v32, v32
    v_sub_f32 v31, v22, v30
    v_sub_f32 v32, v23, v30
    v_fmac_f32 v28, v31, v31
    v_fmac_f32 v33, v32, v32
    v_sub_f32 v31, v24, v30
    v_sub_f32 v32, v25, v30
    v_fmac_f32 v28, v31, v31
    v_fmac_f32 v33, v32, v32
    v_sub_f32 v31, v26, v30
    v_sub_f32 v32, v27, v30
    v_fmac_f32 v28, v31, v31
    v_fmac_f32 v33, v32, v32
    s_mov_b32 exec_hi, -1
    v_add_f32 v28, v28, v33
    s_nop 1
    v_add_f32_dpp v28, v28, v28 quad_perm:[1,0,3,2] row_mask:0xf bank_mask:0xf
    s_nop 1
    v_add_f32_dpp v28, v28, v28 quad_perm:[2,3,0,1] row_mask:0xf bank_mask:0xf
    s_nop 1
    v_add_f32_dpp v28, v28, v28 row_half_mirror row_mask:0xf bank_mask:0xf
    s_nop 1
    v_add_f32_dpp v28, v28, v28 row_mirror row_mask:0xf bank_mask:0xf
    s_nop 1
    v_add_f32_dpp v28, v28, v28 row_bcast:15 row_mask:0xa bank_mask:0xf
    s_nop 1
    v_add_f32_dpp v28, v28, v28 row_bcast:31 row_mask:0xc bank_mask:0xf
    s_nop 0
    v_readlane_b32 s35, v28, 63
    s_nop 1
    v_mul_f32 v31, s35, v29
    v_cvt_pk_bf16_f32 v32, v30, v31
    v_lshlrev_b32 v30, 16, v32
    v_and_b32 v31, 0xffff0000, v32
    v_add_f32 v31, 0x3727c5ac, v31
    v_cvt_pk_bf16_f32 v31, v31, v31
    v_lshlrev_b32 v31, 16, v31
    v_sqrt_f32 v31, v31
    v_sub_f32 v20, v20, v30
    v_sub_f32 v21, v21, v30
    v_sub_f32 v22, v22, v30
    v_sub_f32 v23, v23, v30
    v_sub_f32 v24, v24, v30
    v_sub_f32 v25, v25, v30
    v_sub_f32 v26, v26, v30
    v_sub_f32 v27, v27, v30
    v_cvt_pk_bf16_f32 v31, v31, v31
    v_lshlrev_b32 v31, 16, v31
    v_rcp_f32 v32, v31
    v_cvt_pk_bf16_f32 v8, v20, v21
    v_cvt_pk_bf16_f32 v9, v22, v23
    v_cvt_pk_bf16_f32 v10, v24, v25
    v_cvt_pk_bf16_f32 v11, v26, v27
    v_lshlrev_b32 v20, 16, v8
    v_and_b32 v21, 0xffff0000, v8
    v_lshlrev_b32 v22, 16, v9
    v_and_b32 v23, 0xffff0000, v9
    v_lshlrev_b32 v24, 16, v10
    v_and_b32 v25, 0xffff0000, v10
    v_lshlrev_b32 v26, 16, v11
    v_and_b32 v27, 0xffff0000, v11
    v_mul_f32 v28, v20, v32
    v_fma_f32 v29, -v28, v31, v20
    v_fma_f32 v20, v29, v32, v28
    v_mul_f32 v28, v21, v32
    v_fma_f32 v29, -v28, v31, v21
    v_fma_f32 v21, v29, v32, v28
    v_mul_f32 v28, v22, v32
    v_fma_f32 v29, -v28, v31, v22
    v_fma_f32 v22, v29, v32, v28
    v_mul_f32 v28, v23, v32
    v_fma_f32 v29, -v28, v31, v23
    v_fma_f32 v23, v29, v32, v28
    v_mul_f32 v28, v24, v32
    v_fma_f32 v29, -v28, v31, v24
    v_fma_f32 v24, v29, v32, v28
    v_mul_f32 v28, v25, v32
    v_fma_f32 v29, -v28, v31, v25
    v_fma_f32 v25, v29, v32, v28
    v_mul_f32 v28, v26, v32
    v_fma_f32 v29, -v28, v31, v26
    v_fma_f32 v26, v29, v32, v28
    v_mul_f32 v28, v27, v32
    v_fma_f32 v29, -v28, v31, v27
    v_fma_f32 v27, v29, v32, v28
    v_cvt_pk_bf16_f32 v8, v20, v21
    v_cvt_pk_bf16_f32 v9, v22, v23
    v_cvt_pk_bf16_f32 v10, v24, v25
    v_cvt_pk_bf16_f32 v11, v26, v27
    s_mov_b32 exec_lo, 0
    s_mov_b32 exec_hi, 0xff000000
    v_mov_b32 v8, 0
    v_mov_b32 v9, 0
    v_mov_b32 v10, 0
    v_mov_b32 v11, 0
    s_mov_b64 exec, -1
    s_mov_b32 exec_hi, 0x00ffffff
    ds_write_b128 v2, v[8:11] offset:2944
    s_mov_b32 exec_hi, -1
    v_and_b32 v14, 15, v0
    v_mul_u32_u24 v12, 12, v14
    v_lshlrev_b32 v15, 4, v14
    v_lshrrev_b32 v14, 4, v0
    v_mul_u32_u24 v14, 2176, v14
    v_add_u32 v15, v14, v15
    s_mul_i32 s35, s47, 192
    s_mul_i32 s45, s30, 69632
    s_add_u32 s35, s35, s45
    s_add_u32 s35, s35, 1540096
    s_add_u32 s36, s28, s35
    s_addc_u32 s37, s29, 0
    v_mov_b32 v43, s34
    s_waitcnt vmcnt(0)
    s_waitcnt lgkmcnt(0)
    s_barrier
    s_add_u32 s60, s54, 4194304
    s_addc_u32 s61, s55, 0
    global_load_dwordx4 v[52:55], v45, s[60:61] sc1
    ds_read_b64 v[20:21], v13 offset:3968
    ds_read_b64 v[22:23], v13 offset:4224
    ds_read_b64 v[24:25], v13 offset:4480
    ds_read_b64 v[26:27], v13 offset:4736
    ds_read_b64 v[28:29], v13 offset:4992
    ds_read_b64 v[30:31], v13 offset:5248
    ds_read_b64 v[32:33], v13 offset:5504
    s_waitcnt lgkmcnt(0)
    v_add_f32 v20, v20, v22
    v_add_f32 v24, v24, v26
    v_add_f32 v28, v28, v30
    v_add_f32 v21, v21, v23
    v_add_f32 v25, v25, v27
    v_add_f32 v29, v29, v31
    v_add_f32 v20, v20, v24
    v_add_f32 v28, v28, v32
    v_add_f32 v21, v21, v25
    v_add_f32 v29, v29, v33
    v_add_f32 v20, v20, v28
    v_add_f32 v21, v21, v29
L_px_21:
    s_waitcnt vmcnt(0)
    v_xor_b32 v34, s34, v53
    v_xor_b32 v35, s34, v55
    v_or_b32 v34, v34, v35
    v_cmp_ne_u32 vcc, 0, v34
    s_cbranch_vccz L_pxa_23
    global_load_dwordx4 v[52:55], v45, s[60:61] sc1
    s_waitcnt vmcnt(0)
    v_xor_b32 v34, s34, v53
    v_xor_b32 v35, s34, v55
    v_or_b32 v34, v34, v35
    v_cmp_ne_u32 vcc, 0, v34
    s_cbranch_vccz L_pxa_23
    global_load_dwordx4 v[52:55], v45, s[60:61] sc1
    s_waitcnt vmcnt(0)
    v_xor_b32 v34, s34, v53
    v_xor_b32 v35, s34, v55
    v_or_b32 v34, v34, v35
    v_cmp_ne_u32 vcc, 0, v34
    s_cbranch_vccz L_pxa_23
    global_load_dwordx4 v[52:55], v45, s[60:61] sc1
    s_waitcnt vmcnt(0)
    v_xor_b32 v34, s34, v53
    v_xor_b32 v35, s34, v55
    v_or_b32 v34, v34, v35
    v_cmp_ne_u32 vcc, 0, v34
    s_cbranch_vccz L_pxa_23
    global_load_dwordx4 v[48:51], v45, s[54:55] sc1
    s_waitcnt vmcnt(0)
    v_xor_b32 v34, s34, v49
    v_xor_b32 v35, s34, v51
    v_or_b32 v34, v34, v35
    v_cmp_ne_u32 vcc, 0, v34
    s_cbranch_vccz L_pxd_22
    global_load_dwordx4 v[52:55], v45, s[60:61] sc1
    s_add_u32 s44, s44, 1
    s_cmp_gt_u32 s44, 0x40000
    s_cbranch_scc0 L_px_21
    s_waitcnt vmcnt(0)
    s_branch L_pxd_22
L_pxa_23:
    v_add_f32 v20, v52, v20
    v_add_f32 v21, v54, v21
    s_branch L_pxq
L_pxd_22:
    v_add_f32 v20, v48, v20
    v_add_f32 v21, v50, v21
L_pxq:
    v_cvt_pk_bf16_f32 v30, v20, v21
    ds_bpermute_b32 v40, v12, v30 offset:0
    ds_bpermute_b32 v41, v12, v30 offset:4
    ds_bpermute_b32 v42, v12, v30 offset:8
    s_mov_b32 exec_lo, 0x07ff07ff
    s_mov_b32 exec_hi, 0x07ff07ff
    s_waitcnt lgkmcnt(0)
    global_store_dwordx4 v15, v[40:43], s[36:37] sc1
    s_add_u32 s36, s36, 8704
    s_addc_u32 s37, s37, 0
    global_store_dwordx4 v15, v[40:43], s[36:37] sc1
    s_add_u32 s36, s36, 8704
    s_addc_u32 s37, s37, 0
    global_store_dwordx4 v15, v[40:43], s[36:37] sc1
    s_add_u32 s36, s36, 8704
    s_addc_u32 s37, s37, 0
    global_store_dwordx4 v15, v[40:43], s[36:37] sc1
    s_add_u32 s36, s36, 8704
    s_addc_u32 s37, s37, 0
    global_store_dwordx4 v15, v[40:43], s[36:37] sc1
    s_add_u32 s36, s36, 8704
    s_addc_u32 s37, s37, 0
    global_store_dwordx4 v15, v[40:43], s[36:37] sc1
    s_mov_b64 exec, -1
    v_mov_b32 v14, s34
    s_lshl_b32 s35, s31, 2
    v_mov_b32 v13, s35
    s_getreg_b32 s35, hwreg(HW_REG_XCC_ID, 0, 4)
    s_add_u32 s35, s35, s34
    s_add_u32 s35, s35, 1
    v_mov_b32 v16, s35
    s_mov_b64 exec, 1
    global_store_dword v3, v14, s[38:39] sc1
    s_mov_b64 exec, -1
    s_cmp_eq_u32 s31, 31
    s_cbranch_scc1 L_fin
    s_waitcnt lgkmcnt(0)
    s_barrier
    s_barrier
    v_and_b32 v13, 15, v0
    v_lshlrev_b32 v14, 2, v13
    v_lshlrev_b32 v13, 3, v13
    s_waitcnt lgkmcnt(0)
    s_barrier
    ds_read_b64 v[20:21], v13 offset:3968
    ds_read_b64 v[22:23], v13 offset:4096
    ds_read_b64 v[24:25], v13 offset:4224
    ds_read_b64 v[26:27], v13 offset:4352
    ds_read_b64 v[28:29], v13 offset:4480
    ds_read_b64 v[30:31], v13 offset:4608
    ds_read_b64 v[32:33], v13 offset:4736
    s_waitcnt lgkmcnt(0)
    v_add_f32 v20, v20, v22
    v_add_f32 v24, v24, v26
    v_add_f32 v28, v28, v30
    v_add_f32 v21, v21, v23
    v_add_f32 v25, v25, v27
    v_add_f32 v29, v29, v31
    v_add_f32 v20, v20, v24
    v_add_f32 v28, v28, v32
    v_add_f32 v21, v21, v25
    v_add_f32 v29, v29, v33
    v_add_f32 v20, v20, v28
    v_add_f32 v21, v21, v29
    v_cvt_pk_bf16_f32 v18, v20, v21
    v_lshlrev_b32 v16, 16, v18
    v_and_b32 v17, 0xffff0000, v18
    v_lshlrev_b32 v18, 16, v44
    v_and_b32 v19, 0xffff0000, v44
    v_add_f32 v16, v16, v18
    v_add_f32 v17, v17, v19
    v_cvt_pk_bf16_f32 v18, v16, v17
    v_lshlrev_b32 v16, 16, v18
    v_and_b32 v17, 0xffff0000, v18
    v_mov_b32 v22, 0xc0135761
    v_mul_f32 v18, v16, v16
    v_mul_f32 v19, v17, v17
    v_fmamk_f32 v18, v18, 0xbdd2d3e8, v22
    v_fmamk_f32 v19, v19, 0xbdd2d3e8, v22
    v_mul_f32 v18, v18, v16
    v_mul_f32 v19, v19, v17
    v_exp_f32 v18, v18
    v_exp_f32 v19, v19
    v_add_f32 v18, 1.0, v18
    v_add_f32 v19, 1.0, v19
    v_rcp_f32 v18, v18
    v_rcp_f32 v19, v19
    v_mul_f32 v16, v16, v18
    v_mul_f32 v17, v17, v19
    v_cvt_pk_bf16_f32 v16, v16, v17
    ds_write_b32 v14, v16 offset:3840
    s_waitcnt lgkmcnt(0)
    s_barrier
    s_branch L_fin
L_sv_send:
    s_mul_i32 s35, s30, 69632
    s_sub_u32 s45, s31, 16
    s_lshl_b32 s46, s45, 8
    s_add_u32 s35, s35, s46
    s_add_u32 s35, s35, 524288
    s_add_u32 s60, s28, s35
    s_addc_u32 s61, s29, 0
    s_lshl_b32 s35, s30, 10
    s_lshr_b32 s45, s45, 2
    s_lshl_b32 s45, s45, 9
    s_add_u32 s35, s35, s45
    s_add_u32 s35, s35, 131072
    s_add_u32 s52, s28, s35
    s_addc_u32 s53, s29, 0
    v_lshrrev_b32 v104, 4, v0
    v_mul_u32_u24 v100, 2176, v104
    v_and_b32 v102, 15, v0
    v_lshl_add_u32 v100, v102, 4, v100
    v_add_u32 v105, 8704, v100
    v_add_u32 v106, 17408, v100
    v_add_u32 v107, 26112, v100
    v_add_u32 v108, 34816, v100
    v_add_u32 v109, 43520, v100
    v_lshlrev_b32 v104, 2, v104
    v_lshlrev_b32 v102, 3, v102
    v_min_u32 v103, 23, v0
    v_lshlrev_b32 v101, 4, v103
    v_lshlrev_b32 v103, 2, v103
    s_waitcnt vmcnt(0)
    s_waitcnt lgkmcnt(0)
    s_barrier
    ds_read_b64 v[20:21], v13 offset:3968
    ds_read_b64 v[22:23], v13 offset:4224
    ds_read_b64 v[24:25], v13 offset:4480
    ds_read_b64 v[26:27], v13 offset:4736
    ds_read_b64 v[28:29], v13 offset:4992
    ds_read_b64 v[30:31], v13 offset:5248
    ds_read_b64 v[32:33], v13 offset:5504
    s_waitcnt lgkmcnt(0)
    v_add_f32 v20, v20, v22
    v_add_f32 v24, v24, v26
    v_add_f32 v28, v28, v30
    v_add_f32 v21, v21, v23
    v_add_f32 v25, v25, v27
    v_add_f32 v29, v29, v31
    v_add_f32 v20, v20, v24
    v_add_f32 v28, v28, v32
    v_add_f32 v21, v21, v25
    v_add_f32 v29, v29, v33
    v_add_f32 v20, v20, v28
    v_add_f32 v21, v21, v29
    v_mov_b32 v22, v21
    v_mov_b32 v21, s34
    v_mov_b32 v23, s34
    s_mov_b32 exec_hi, 0
    s_add_u32 s36, s54, 4194304
    s_addc_u32 s37, s55, 0
    global_store_dwordx4 v45, v[20:23], s[36:37]
    global_store_dwordx4 v45, v[20:23], s[54:55] sc1
    s_mov_b32 exec_hi, -1
    v_mov_b32 v14, s34
    s_lshl_b32 s35, s31, 2
    v_mov_b32 v13, s35
    s_getreg_b32 s35, hwreg(HW_REG_XCC_ID, 0, 4)
    s_add_u32 s35, s35, s34
    s_add_u32 s35, s35, 1
    v_mov_b32 v16, s35
    s_mov_b64 exec, 1
    global_store_dword v13, v16, s[40:41] sc1
    global_store_dword v3, v14, s[38:39] sc1
    s_mov_b64 exec, -1
    s_add_u32 s46, s60, 4194304
    s_addc_u32 s47, s61, 0
    s_add_u32 s48, s52, 4194304
    s_addc_u32 s49, s53, 0
    global_load_dwordx4 v[64:67], v101, s[48:49] sc1
    global_load_dwordx4 v[68:71], v100, s[46:47] sc1
    global_load_dwordx4 v[72:75], v105, s[46:47] sc1
    global_load_dwordx4 v[76:79], v106, s[46:47] sc1
    global_load_dwordx4 v[80:83], v107, s[46:47] sc1
    global_load_dwordx4 v[84:87], v108, s[46:47] sc1
    global_load_dwordx4 v[88:91], v109, s[46:47] sc1
    s_barrier
    s_load_dwordx16 s[8:23], s[58:59], 0 glc
    s_load_dwordx16 s[64:79], s[58:59], 64 glc
    s_load_dwordx16 s[80:95], s[58:59], 128 glc
L_sq_24:
    s_waitcnt lgkmcnt(0)
    s_cmp_lg_u32 s11, s34
    s_cbranch_scc1 L_sqr_25
    s_cmp_lg_u32 s15, s34
    s_cbranch_scc1 L_sqr_25
    s_cmp_lg_u32 s19, s34
    s_cbranch_scc1 L_sqr_25
    s_cmp_lg_u32 s23, s34
    s_cbranch_scc1 L_sqr_25
    s_cmp_lg_u32 s67, s34
    s_cbranch_scc1 L_sqr_25
    s_cmp_lg_u32 s71, s34
    s_cbranch_scc1 L_sqr_25
    s_cmp_lg_u32 s75, s34
    s_cbranch_scc1 L_sqr_25
    s_cmp_lg_u32 s79, s34
    s_cbranch_scc1 L_sqr_25
    s_cmp_lg_u32 s83, s34
    s_cbranch_scc1 L_sqr_25
    s_cmp_lg_u32 s87, s34
    s_cbranch_scc1 L_sqr_25
    s_cmp_lg_u32 s91, s34
    s_cbranch_scc1 L_sqr_25
    s_branch L_sqd_26
L_sqr_25:
    s_load_dwordx16 s[8:23], s[58:59], 0 glc
    s_load_dwordx16 s[64:79], s[58:59], 64 glc
    s_load_dwordx16 s[80:95], s[58:59], 128 glc
    s_add_u32 s44, s44, 1
    s_cmp_gt_u32 s44, 0x40000
    s_cbranch_scc0 L_sq_24
    s_waitcnt lgkmcnt(0)
L_sqd_26:
    v_writelane_b32 v8, s8, 0
    v_writelane_b32 v8, s9, 1
    v_writelane_b32 v8, s10, 2
    v_writelane_b32 v8, s12, 3
    v_writelane_b32 v8, s13, 4
    v_writelane_b32 v8, s14, 5
    v_writelane_b32 v8, s16, 6
    v_writelane_b32 v8, s17, 7
    v_writelane_b32 v8, s18, 8
    v_writelane_b32 v8, s20, 9
    v_writelane_b32 v8, s21, 10
    v_writelane_b32 v8, s22, 11
    v_writelane_b32 v8, s64, 12
    v_writelane_b32 v8, s65, 13
    v_writelane_b32 v8, s66, 14
    v_writelane_b32 v8, s68, 15
    v_writelane_b32 v8, s69, 16
    v_writelane_b32 v8, s70, 17
    v_writelane_b32 v8, s72, 18
    v_writelane_b32 v8, s73, 19
    v_writelane_b32 v8, s74, 20
    v_writelane_b32 v8, s76, 21
    v_writelane_b32 v8, s77, 22
    v_writelane_b32 v8, s78, 23
    v_writelane_b32 v8, s80, 24
    v_writelane_b32 v8, s81, 25
    v_writelane_b32 v8, s82, 26
    v_writelane_b32 v8, s84, 27
    v_writelane_b32 v8, s85, 28
    v_writelane_b32 v8, s86, 29
    v_writelane_b32 v8, s88, 30
    v_writelane_b32 v8, s89, 31
    s_mov_b32 exec_hi, 0
    ds_write_b32 v19, v8
    s_mov_b32 exec_hi, -1
    s_waitcnt lgkmcnt(0)
    s_barrier
    s_waitcnt lgkmcnt(0)
    s_barrier
    s_waitcnt lgkmcnt(0)
    s_barrier
    ds_read2st64_b32 v[8:9], v17 offset0:24 offset1:32
    s_waitcnt lgkmcnt(0)
    v_add_f32 v8, v8, v9
    v_min_u32 v8, -2, v8
    s_add_u32 s58, s56, 4194304
    s_addc_u32 s59, s57, 0
    global_store_dword v17, v8, s[58:59]
    global_store_dword v17, v8, s[56:57] sc1
    ds_read_b128 v[20:23], v36 offset:1792
    ds_read_b128 v[24:27], v36 offset:1808
    ds_read_b128 v[28:31], v36 offset:1856
    ds_read_b128 v[32:35], v36 offset:1872
    s_waitcnt lgkmcnt(0)
    v_max3_f32 v40, v20, v21, v22
    v_max3_f32 v23, v23, v24, v25
    v_add_f32 v28, v28, v29
    v_add_f32 v30, v30, v31
    v_add_f32 v32, v32, v33
    v_add_f32 v34, v34, v35
    v_max3_f32 v40, v40, v26, v27
    v_add_f32 v28, v28, v30
    v_add_f32 v32, v32, v34
    v_max_f32 v40, v40, v23
    v_add_f32 v42, v28, v32
    v_mov_b32 v41, s34
    v_mov_b32 v43, s34
    s_mov_b64 exec, 3
    s_add_u32 s58, s42, 4194304
    s_addc_u32 s59, s43, 0
    global_store_dwordx4 v37, v[40:43], s[58:59]
    global_store_dwordx4 v37, v[40:43], s[42:43] sc1
    s_mov_b64 exec, -1
    s_add_u32 s35, s34, 1
L_lt_27:
    global_load_dword v81, v103, s[40:41] sc1
    s_waitcnt vmcnt(0)
    v_subrev_u32 v81, s35, v81
    v_cmp_le_u32 vcc, 16, v81
    s_cbranch_vccz L_ld_28
    s_add_u32 s44, s44, 1
    s_cmp_gt_u32 s44, 0x40000
    s_cbranch_scc0 L_lt_27
L_ld_28:
    s_getreg_b32 s35, hwreg(HW_REG_XCC_ID, 0, 4)
    v_cmp_ne_u32 vcc, s35, v81
    s_nop 0
    s_cmp_eq_u64 vcc, 0
    s_cselect_b32 s35, 4194304, 0
    s_add_u32 s60, s60, s35
    s_addc_u32 s61, s61, 0
    s_add_u32 s52, s52, s35
    s_addc_u32 s53, s53, 0
L_pl_29:
    global_load_dwordx4 v[64:67], v101, s[52:53] sc1
    global_load_dwordx4 v[40:43], v100, s[60:61] sc1
    global_load_dwordx4 v[44:47], v105, s[60:61] sc1
    global_load_dwordx4 v[48:51], v106, s[60:61] sc1
    global_load_dwordx4 v[52:55], v107, s[60:61] sc1
    global_load_dwordx4 v[56:59], v108, s[60:61] sc1
    global_load_dwordx4 v[60:63], v109, s[60:61] sc1
    s_waitcnt vmcnt(0)
    v_max3_u32 v88, v40, v41, v42
    v_max3_u32 v89, v43, v44, v45
    v_max3_u32 v90, v46, v47, v48
    v_max3_u32 v91, v49, v50, v51
    v_max3_u32 v92, v52, v53, v54
    v_max3_u32 v93, v55, v56, v57
    v_max3_u32 v94, v58, v59, v60
    v_max3_u32 v95, v61, v62, v63
    v_xor_b32 v80, s34, v65
    v_xor_b32 v81, s34, v67
    v_max3_u32 v88, v88, v89, v90
    v_max3_u32 v91, v91, v92, v93
    v_or_b32 v80, v80, v81
    v_max3_u32 v88, v88, v94, v95
    v_cmp_ne_u32 s[54:55], 0, v80
    v_max_u32 v88, v88, v91
    v_cmp_eq_u32 vcc, -1, v88
    s_nop 0
    s_or_b64 vcc, vcc, s[54:55]
    s_cbranch_vccz L_pd_30
    s_mov_b64 exec, vcc
    s_add_u32 s44, s44, 1
    s_cmp_gt_u32 s44, 0x40000
    s_cbranch_scc0 L_pl_29
L_pd_30:
    s_mov_b64 exec, -1
    v_max_f32_dpp v80, v64, v64 quad_perm:[1,0,3,2] row_mask:0xf bank_mask:0xf
    s_nop 1
    v_max_f32_dpp v80, v80, v80 quad_perm:[2,3,0,1] row_mask:0xf bank_mask:0xf
    s_nop 1
    v_max_f32_dpp v80, v80, v80 row_half_mirror row_mask:0xf bank_mask:0xf
    s_nop 1
    v_max_f32_dpp v80, v80, v80 row_mirror row_mask:0xf bank_mask:0xf
    s_nop 1
    v_max_f32_dpp v80, v80, v80 row_bcast:15 row_mask:0xa bank_mask:0xf
    s_nop 0
    v_readlane_b32 s35, v80, 31
    s_nop 1
    v_subrev_f32 v81, s35, v64
    v_mul_f32 v81, 0x3db8aa3b, v81
    v_exp_f32 v81, v81
    s_nop 0
    ds_bpermute_b32 v82, v104, v81 offset:0
    ds_bpermute_b32 v83, v104, v81 offset:16
    ds_bpermute_b32 v84, v104, v81 offset:32
    ds_bpermute_b32 v85, v104, v81 offset:48
    ds_bpermute_b32 v86, v104, v81 offset:64
    ds_bpermute_b32 v87, v104, v81 offset:80
    v_mul_f32 v88, v81, v66
    v_cmp_gt_u32 vcc, 24, v0
    s_nop 1
    v_cndmask_b32 v88, 0, v88, vcc
    s_nop 1
    v_add_f32_dpp v88, v88, v88 quad_perm:[1,0,3,2] row_mask:0xf bank_mask:0xf
    s_nop 1
    v_add_f32_dpp v88, v88, v88 quad_perm:[2,3,0,1] row_mask:0xf bank_mask:0xf
    s_nop 1
    v_add_f32_dpp v88, v88, v88 row_half_mirror row_mask:0xf bank_mask:0xf
    s_nop 1
    v_add_f32_dpp v88, v88, v88 row_mirror row_mask:0xf bank_mask:0xf
    s_nop 1
    v_add_f32_dpp v88, v88, v88 row_bcast:15 row_mask:0xa bank_mask:0xf
    s_nop 0
    v_readlane_b32 s35, v88, 31
    s_nop 1
    v_rcp_f32 v89, s35
    s_waitcnt lgkmcnt(0)
    v_mul_f32 v90, v82, v40
    v_mul_f32 v91, v82, v41
    v_mul_f32 v92, v82, v42
    v_mul_f32 v93, v82, v43
    v_fmac_f32 v90, v83, v44
    v_fmac_f32 v91, v83, v45
    v_fmac_f32 v92, v83, v46
    v_fmac_f32 v93, v83, v47
    v_fmac_f32 v90, v84, v48
    v_fmac_f32 v91, v84, v49
    v_fmac_f32 v92, v84, v50
    v_fmac_f32 v93, v84, v51
    v_fmac_f32 v90, v85, v52
    v_fmac_f32 v91, v85, v53
    v_fmac_f32 v92, v85, v54
    v_fmac_f32 v93, v85, v55
    v_fmac_f32 v90, v86, v56
    v_fmac_f32 v91, v86, v57
    v_fmac_f32 v92, v86, v58
    v_fmac_f32 v93, v86, v59
    v_fmac_f32 v90, v87, v60
    v_fmac_f32 v91, v87, v61
    v_fmac_f32 v92, v87, v62
    v_fmac_f32 v93, v87, v63
    s_nop 0
    v_permlane32_swap_b32 v90, v92
    v_permlane32_swap_b32 v91, v93
    v_add_f32 v90, v90, v92
    v_add_f32 v91, v91, v93
    v_mov_b32 v92, v90
    v_mov_b32 v93, v91
    s_nop 0
    v_permlane16_swap_b32 v90, v92
    v_permlane16_swap_b32 v91, v93
    v_add_f32 v90, v90, v92
    v_add_f32 v91, v91, v93
    v_mul_f32 v90, v90, v89
    v_mul_f32 v91, v91, v89
    v_cvt_pk_bf16_f32 v90, v90, v91
    v_lshrrev_b32 v91, 5, v0
    v_lshl_add_u32 v91, v91, 2, v102
    ds_write_b32 v91, v90 offset:1920
    s_waitcnt lgkmcnt(0)
    s_barrier
L_fin:
L_end:
s_endpgm
.section .rodata,"a"
.p2align 6
.amdhsa_kernel parallel_sum__sliding_block_cached__mixer_channel_mlp__decode_kernel
  .amdhsa_next_free_vgpr 128
  .amdhsa_next_free_sgpr 102
  .amdhsa_accum_offset 128
  .amdhsa_group_segment_fixed_size 0
  .amdhsa_kernarg_size 104
  .amdhsa_user_sgpr_count 2
  .amdhsa_user_sgpr_kernarg_segment_ptr 1
  .amdhsa_system_sgpr_workgroup_id_x 1
.end_amdhsa_kernel
```
